```python
import torch

def _softmax(x, axis=-1):
    return torch.softmax(x, dim=axis)
def _gelu(x):
    return torch.nn.functional.gelu(x, approximate="tanh")
def _silu(x):
    return torch.nn.functional.silu(x)
def _sigmoid(x):
    return torch.sigmoid(x)
def _layernorm(x, axis=-1, eps=1e-5):
    m = x.mean(dim=axis, keepdim=True)
    v = x.var(dim=axis, keepdim=True, unbiased=False)
    return (x - m) / torch.sqrt(v + eps)
def _scatter_add(tgt, idx, src, axis=0):
    return tgt.clone().index_add_(axis, idx, src)
def _segment_sum(src, seg, n):
    out = torch.zeros((n,) + src.shape[1:], dtype=src.dtype)
    return out.index_add_(0, seg, src)
def _pad(x, pw):
    flat = tuple(v for pair in reversed(pw) for v in pair)
    return torch.nn.functional.pad(x, flat)

kernel_name = 'gated_mix__mha_block__dense_activation_mish__prompt'

def setup_inputs():

    _w = (lambda a: (lambda t: t.to(torch.bfloat16) if t.is_floating_point() else t)(torch.as_tensor(a)))
    def _A_setup():
        B, S, D, H = 1, 2048, 512, 32
        return {
            "x": _w((lambda *s: torch.randn(*s, dtype=torch.bfloat16) * 0.05)(B, S, D)),
            "wqkv": _w((lambda *s: torch.randn(*s, dtype=torch.bfloat16) * 0.8)(D, 3 * D)),
            "wo": _w((lambda *s: torch.randn(*s, dtype=torch.bfloat16) * 0.05)(D, D)),
        }
    _A_in = _A_setup()

    def _B_setup():
        B, S, D, F = 1, 2048, 512, 1792
        return {
            "x": _w((lambda *s: torch.randn(*s, dtype=torch.bfloat16) * 0.05)(B, S, D)),
            "w1": _w((lambda *s: torch.randn(*s, dtype=torch.bfloat16) * 12.8)(D, F) * (D ** -0.5)),
            "b1": _w((lambda *s: torch.randn(*s, dtype=torch.bfloat16) * 0.2)(F)),
            "w2": _w((lambda *s: torch.randn(*s, dtype=torch.bfloat16) * 0.1)(F, D) * (F ** -0.5)),
        }
    _B_in = _B_setup()

    return {
        "A_x": _A_in["x"],
        "A_wqkv": _A_in["wqkv"],
        "A_wo": _A_in["wo"],
        "B_x": _B_in["x"],
        "B_w1": _B_in["w1"],
        "B_b1": _B_in["b1"],
        "B_w2": _B_in["w2"],
        "gate_w": _w((lambda *s: torch.randn(*s, dtype=torch.bfloat16) * 0.05)(512) * 16.0),
    }

def reference(A_x, A_wqkv, A_wo, B_x, B_w1, B_b1, B_w2, gate_w):
    def _A_ref(x, wqkv, wo):
        B, S, D = x.shape
        H = 32
        Dh = D // H
        qkv = (lambda x, *d: x.permute(*d))((x @ wqkv).reshape(B, S, 3, H, Dh), 2, 0, 3, 1, 4)
        q, k, v = qkv[0], qkv[1], qkv[2]
        scores = torch.einsum("bhqd,bhkd->bhqk", q, k) * (Dh ** -0.5)
        p = _softmax(scores, axis=-1)
        o = torch.einsum("bhqk,bhkd->bhqd", p, v)
        return (lambda x, *d: x.permute(*d))(o, 0, 2, 1, 3).reshape(B, S, D) @ wo

    def _B_ref(x, w1, b1, w2):
        h = torch.einsum("bsd,df->bsf", x, w1) + b1
        sp = torch.log1p(torch.exp(-torch.abs(h))) + torch.where(h > 0, h, torch.zeros_like(h))
        act = h * torch.tanh(sp)
        return torch.einsum("bsf,fd->bsd", act, w2)

    x = A_x
    g = _sigmoid((x * gate_w).sum(-1, keepdims=True))
    a = _A_ref(x, A_wqkv, A_wo)
    b = _B_ref(x, B_w1, B_b1, B_w2)
    return g * a + (1 - g) * b
```

```asm
; @launch grid=(256,1,1) block=(768,1,1) lds=163840
.amdgcn_target "amdgcn-amd-amdhsa--gfx950"
.text
.globl gated_mix__mha_block__dense_activation_mish__prompt_kernel
.p2align 8
.type gated_mix__mha_block__dense_activation_mish__prompt_kernel,@function
gated_mix__mha_block__dense_activation_mish__prompt_kernel:
    s_cmp_ge_u32 s2, 256
    s_cbranch_scc1 K_END
    s_load_dwordx16 s[4:19], s[0:1], 0
    s_load_dwordx4 s[20:23], s[0:1], 64
    s_load_dwordx2 s[24:25], s[0:1], 80
    v_and_b32 v1, 63, v0
    v_lshrrev_b32 v3, 6, v0
    v_lshlrev_b32 v2, 4, v1
    v_readfirstlane_b32 s68, v3
    v_lshlrev_b32 v3, 6, v0
    s_cmp_ge_u32 s68, 4
    s_cbranch_scc1 K_NOPC
    s_getpc_b64 s[74:75]
K_PC:
    v_min_u32 v3, K_END-K_PC, v3
    global_load_dword v12, v3, s[74:75]
K_NOPC:
    s_and_b32 s74, s2, 7
    s_lshr_b32 s75, s2, 3
    s_and_b32 s69, s74, 1
    s_lshl_b32 s69, s69, 3
    s_and_b32 s76, s75, 7
    s_add_u32 s69, s69, s76
    s_lshr_b32 s70, s74, 1
    s_lshl_b32 s70, s70, 2
    s_lshr_b32 s76, s75, 3
    s_add_u32 s70, s70, s76
    s_and_b32 s71, s68, 3
    s_lshl_b32 s72, s69, 2
    s_add_u32 s72, s72, s71
    s_sub_u32 s74, s70, 2
    s_cmp_ge_u32 s70, 14
    s_cselect_b32 s73, s74, s70
    s_lshl_b32 s73, s73, 2
    s_cmp_ge_u32 s68, 8
    s_cbranch_scc1 G_START
    s_branch A_START
G_START:
    s_setprio 3
    s_lshl_b32 s26, s72, 15
    s_lshl_b32 s27, s71, 12
    s_mul_i32 s80, s71, 49152
    s_lshl_b32 s74, s70, 6
    s_add_u32 s80, s80, s74
    v_lshrrev_b32 v3, 3, v1
    v_lshrrev_b32 v4, 4, v1
    v_and_b32 v9, 7, v1
    v_xor_b32 v9, v9, v4
    v_lshlrev_b32 v5, 10, v3
    v_lshl_add_u32 v5, v9, 4, v5
    v_xor_b32 v6, 64, v5
    v_add_u32 v6, 8192, v6
    v_lshrrev_b32 v3, 2, v1
    v_and_b32 v9, 3, v1
    v_lshlrev_b32 v9, 4, v9
    v_mul_u32_u24 v7, 3072, v3
    v_add_u32 v7, v7, v9
    v_mul_u32_u24 v8, 3584, v3
    v_add_u32 v8, v8, v9
    s_lshl_b32 s3, s71, 10
    s_waitcnt lgkmcnt(0)
    s_mov_b32 s28, s4
    s_and_b32 s29, s5, 0xffff
    s_mov_b32 s30, 0x200000
    s_mov_b32 s31, 0x00020000
    s_mov_b32 s32, s6
    s_and_b32 s33, s7, 0xffff
    s_mov_b32 s34, 0x180000
    s_mov_b32 s35, 0x00020000
    s_mov_b32 s56, s18
    s_and_b32 s57, s19, 0xffff
    s_mov_b32 s58, 0x400
    s_mov_b32 s59, 0x00020000
    s_lshr_b32 s82, s2, 3
    s_lshr_b32 s75, s2, 6
    s_lshl_b32 s75, s75, 1
    s_add_u32 s82, s82, s75
    s_and_b32 s82, s82, 7
    s_lshl_b32 s75, s82, 7
    v_add_u32 v10, s75, v2
    v_and_b32 v10, 0x3ff, v10
    s_mov_b32 m0, 147456
    s_nop 0
    buffer_load_dwordx4 v10, s[56:59], 0 offen lds
    s_add_u32 s75, s82, 0
    s_and_b32 s75, s75, 7
    s_lshl_b32 s83, s75, 7
    s_add_u32 s83, s83, s26
    s_mul_i32 s76, s75, 196608
    s_add_u32 s76, s76, s80
    s_add_u32 m0, s27, 0
    s_add_u32 s74, s83, 0
    buffer_load_dwordx4 v5, s[28:31], s74 offen lds
    s_add_u32 m0, s27, 1024
    s_add_u32 s74, s83, 0
    buffer_load_dwordx4 v6, s[28:31], s74 offen lds
    s_add_u32 m0, s27, 2048
    s_add_u32 s74, s83, 16384
    buffer_load_dwordx4 v5, s[28:31], s74 offen lds
    s_add_u32 m0, s27, 3072
    s_add_u32 s74, s83, 16384
    buffer_load_dwordx4 v6, s[28:31], s74 offen lds
    s_add_u32 m0, s3, 16384
    s_add_u32 s74, s76, 0
    buffer_load_dwordx4 v7, s[32:35], s74 offen lds
    s_add_u32 m0, s3, 20480
    s_add_u32 s74, s76, 1024
    buffer_load_dwordx4 v7, s[32:35], s74 offen lds
    s_add_u32 m0, s3, 24576
    s_add_u32 s74, s76, 2048
    buffer_load_dwordx4 v7, s[32:35], s74 offen lds
    s_add_u32 s75, s82, 1
    s_and_b32 s75, s75, 7
    s_lshl_b32 s83, s75, 7
    s_add_u32 s83, s83, s26
    s_mul_i32 s76, s75, 196608
    s_add_u32 s76, s76, s80
    s_add_u32 m0, s27, 32768
    s_add_u32 s74, s83, 0
    buffer_load_dwordx4 v5, s[28:31], s74 offen lds
    s_add_u32 m0, s27, 33792
    s_add_u32 s74, s83, 0
    buffer_load_dwordx4 v6, s[28:31], s74 offen lds
    s_add_u32 m0, s27, 34816
    s_add_u32 s74, s83, 16384
    buffer_load_dwordx4 v5, s[28:31], s74 offen lds
    s_add_u32 m0, s27, 35840
    s_add_u32 s74, s83, 16384
    buffer_load_dwordx4 v6, s[28:31], s74 offen lds
    s_add_u32 m0, s3, 49152
    s_add_u32 s74, s76, 0
    buffer_load_dwordx4 v7, s[32:35], s74 offen lds
    s_add_u32 m0, s3, 53248
    s_add_u32 s74, s76, 1024
    buffer_load_dwordx4 v7, s[32:35], s74 offen lds
    s_add_u32 m0, s3, 57344
    s_add_u32 s74, s76, 2048
    buffer_load_dwordx4 v7, s[32:35], s74 offen lds
    s_mov_b32 s36, s12
    s_and_b32 s37, s13, 0xffff
    s_mov_b32 s38, 0x1c0000
    s_mov_b32 s39, 0x00020000
    s_mov_b32 s40, s24
    s_and_b32 s41, s25, 0xffff
    s_mov_b32 s42, 0x10000000
    s_mov_b32 s43, 0x00020000
    s_mov_b32 s44, s14
    s_and_b32 s45, s15, 0xffff
    s_mov_b32 s46, 0xe00
    s_mov_b32 s47, 0x00020000
    s_mov_b32 s48, s16
    s_and_b32 s49, s17, 0xffff
    s_mov_b32 s50, 0x1c0000
    s_mov_b32 s51, 0x00020000
    s_mov_b32 s52, s8
    s_and_b32 s53, s9, 0xffff
    s_mov_b32 s54, 0x80000
    s_mov_b32 s55, 0x00020000
    s_mov_b32 s60, s20
    s_and_b32 s61, s21, 0xffff
    s_mov_b32 s62, 0x200000
    s_mov_b32 s63, 0x00020000
    s_mov_b32 s64, s22
    s_and_b32 s65, s23, 0xffff
    s_mov_b32 s66, 0x100
    s_mov_b32 s67, 0x00020000
    s_mul_i32 s81, s71, 57344
    s_lshl_b32 s74, s73, 6
    s_add_u32 s81, s81, s74
    s_cmp_ge_u32 s70, 14
    s_cselect_b32 s81, 0x40000000, s81
    s_mov_b32 m0, 148480
    s_lshl_b32 s74, s73, 6
    buffer_load_dwordx4 v2, s[44:47], s74 offen lds
    s_lshl_b32 s74, s2, 4
    s_add_u32 s74, s74, s68
    s_cmp_eq_u32 s74, 8
    s_cbranch_scc0 G_NOEP
    s_memrealtime s[78:79]
    s_waitcnt lgkmcnt(0)
    s_or_b32 s78, s78, 1
    v_mov_b32 v14, s78
    v_mov_b32 v15, s79
    s_mov_b64 exec, 1
    buffer_store_dwordx2 v[14:15], off, s[64:67], 0 sc1
    s_mov_b64 exec, -1
G_NOEP:
    s_waitcnt vmcnt(8)
    s_barrier
    s_add_u32 s75, s82, 2
    s_and_b32 s75, s75, 7
    s_lshl_b32 s83, s75, 7
    s_add_u32 s83, s83, s26
    s_mul_i32 s76, s75, 196608
    s_add_u32 s76, s76, s80
    s_add_u32 m0, s27, 65536
    s_add_u32 s74, s83, 0
    buffer_load_dwordx4 v5, s[28:31], s74 offen lds
    s_add_u32 m0, s27, 66560
    s_add_u32 s74, s83, 0
    buffer_load_dwordx4 v6, s[28:31], s74 offen lds
    s_add_u32 m0, s27, 67584
    s_add_u32 s74, s83, 16384
    buffer_load_dwordx4 v5, s[28:31], s74 offen lds
    s_add_u32 m0, s27, 68608
    s_add_u32 s74, s83, 16384
    buffer_load_dwordx4 v6, s[28:31], s74 offen lds
    s_add_u32 m0, s3, 81920
    s_add_u32 s74, s76, 0
    buffer_load_dwordx4 v7, s[32:35], s74 offen lds
    s_add_u32 m0, s3, 86016
    s_add_u32 s74, s76, 1024
    buffer_load_dwordx4 v7, s[32:35], s74 offen lds
    s_add_u32 m0, s3, 90112
    s_add_u32 s74, s76, 2048
    buffer_load_dwordx4 v7, s[32:35], s74 offen lds
    s_add_u32 s75, s82, 3
    s_and_b32 s75, s75, 7
    s_lshl_b32 s83, s75, 7
    s_add_u32 s83, s83, s26
    s_mul_i32 s76, s75, 196608
    s_add_u32 s76, s76, s80
    s_add_u32 m0, s27, 98304
    s_add_u32 s74, s83, 0
    buffer_load_dwordx4 v5, s[28:31], s74 offen lds
    s_add_u32 m0, s27, 99328
    s_add_u32 s74, s83, 0
    buffer_load_dwordx4 v6, s[28:31], s74 offen lds
    s_add_u32 m0, s27, 100352
    s_add_u32 s74, s83, 16384
    buffer_load_dwordx4 v5, s[28:31], s74 offen lds
    s_add_u32 m0, s27, 101376
    s_add_u32 s74, s83, 16384
    buffer_load_dwordx4 v6, s[28:31], s74 offen lds
    s_add_u32 m0, s3, 114688
    s_add_u32 s74, s76, 0
    buffer_load_dwordx4 v7, s[32:35], s74 offen lds
    s_add_u32 m0, s3, 118784
    s_add_u32 s74, s76, 1024
    buffer_load_dwordx4 v7, s[32:35], s74 offen lds
    s_add_u32 m0, s3, 122880
    s_add_u32 s74, s76, 2048
    buffer_load_dwordx4 v7, s[32:35], s74 offen lds
    s_waitcnt vmcnt(14)
    s_barrier
    s_waitcnt vmcnt(7)
    s_barrier
    s_add_u32 s75, s82, 4
    s_and_b32 s75, s75, 7
    s_lshl_b32 s83, s75, 7
    s_add_u32 s83, s83, s26
    s_mul_i32 s76, s75, 196608
    s_add_u32 s76, s76, s80
    s_add_u32 m0, s27, 0
    s_add_u32 s74, s83, 0
    buffer_load_dwordx4 v5, s[28:31], s74 offen lds
    s_add_u32 m0, s27, 1024
    s_add_u32 s74, s83, 0
    buffer_load_dwordx4 v6, s[28:31], s74 offen lds
    s_add_u32 m0, s27, 2048
    s_add_u32 s74, s83, 16384
    buffer_load_dwordx4 v5, s[28:31], s74 offen lds
    s_add_u32 m0, s27, 3072
    s_add_u32 s74, s83, 16384
    buffer_load_dwordx4 v6, s[28:31], s74 offen lds
    s_add_u32 m0, s3, 16384
    s_add_u32 s74, s76, 0
    buffer_load_dwordx4 v7, s[32:35], s74 offen lds
    s_add_u32 m0, s3, 20480
    s_add_u32 s74, s76, 1024
    buffer_load_dwordx4 v7, s[32:35], s74 offen lds
    s_add_u32 m0, s3, 24576
    s_add_u32 s74, s76, 2048
    buffer_load_dwordx4 v7, s[32:35], s74 offen lds
    s_waitcnt vmcnt(7)
    s_barrier
    s_add_u32 s75, s82, 5
    s_and_b32 s75, s75, 7
    s_lshl_b32 s83, s75, 7
    s_add_u32 s83, s83, s26
    s_mul_i32 s76, s75, 196608
    s_add_u32 s76, s76, s80
    s_add_u32 m0, s27, 32768
    s_add_u32 s74, s83, 0
    buffer_load_dwordx4 v5, s[28:31], s74 offen lds
    s_add_u32 m0, s27, 33792
    s_add_u32 s74, s83, 0
    buffer_load_dwordx4 v6, s[28:31], s74 offen lds
    s_add_u32 m0, s27, 34816
    s_add_u32 s74, s83, 16384
    buffer_load_dwordx4 v5, s[28:31], s74 offen lds
    s_add_u32 m0, s27, 35840
    s_add_u32 s74, s83, 16384
    buffer_load_dwordx4 v6, s[28:31], s74 offen lds
    s_add_u32 m0, s3, 49152
    s_add_u32 s74, s76, 0
    buffer_load_dwordx4 v7, s[32:35], s74 offen lds
    s_add_u32 m0, s3, 53248
    s_add_u32 s74, s76, 1024
    buffer_load_dwordx4 v7, s[32:35], s74 offen lds
    s_add_u32 m0, s3, 57344
    s_add_u32 s74, s76, 2048
    buffer_load_dwordx4 v7, s[32:35], s74 offen lds
    s_waitcnt vmcnt(7)
    s_barrier
    s_add_u32 s75, s82, 6
    s_and_b32 s75, s75, 7
    s_lshl_b32 s83, s75, 7
    s_add_u32 s83, s83, s26
    s_mul_i32 s76, s75, 196608
    s_add_u32 s76, s76, s80
    s_add_u32 m0, s27, 65536
    s_add_u32 s74, s83, 0
    buffer_load_dwordx4 v5, s[28:31], s74 offen lds
    s_add_u32 m0, s27, 66560
    s_add_u32 s74, s83, 0
    buffer_load_dwordx4 v6, s[28:31], s74 offen lds
    s_add_u32 m0, s27, 67584
    s_add_u32 s74, s83, 16384
    buffer_load_dwordx4 v5, s[28:31], s74 offen lds
    s_add_u32 m0, s27, 68608
    s_add_u32 s74, s83, 16384
    buffer_load_dwordx4 v6, s[28:31], s74 offen lds
    s_add_u32 m0, s3, 81920
    s_add_u32 s74, s76, 0
    buffer_load_dwordx4 v7, s[32:35], s74 offen lds
    s_add_u32 m0, s3, 86016
    s_add_u32 s74, s76, 1024
    buffer_load_dwordx4 v7, s[32:35], s74 offen lds
    s_add_u32 m0, s3, 90112
    s_add_u32 s74, s76, 2048
    buffer_load_dwordx4 v7, s[32:35], s74 offen lds
    buffer_load_dwordx2 v[14:15], off, s[64:67], 0 sc1
    s_waitcnt vmcnt(8)
    s_barrier
    s_add_u32 s75, s82, 7
    s_and_b32 s75, s75, 7
    s_lshl_b32 s83, s75, 7
    s_add_u32 s83, s83, s26
    s_mul_i32 s76, s75, 196608
    s_add_u32 s76, s76, s80
    s_add_u32 m0, s27, 98304
    s_add_u32 s74, s83, 0
    buffer_load_dwordx4 v5, s[28:31], s74 offen lds
    s_add_u32 m0, s27, 99328
    s_add_u32 s74, s83, 0
    buffer_load_dwordx4 v6, s[28:31], s74 offen lds
    s_add_u32 m0, s27, 100352
    s_add_u32 s74, s83, 16384
    buffer_load_dwordx4 v5, s[28:31], s74 offen lds
    s_add_u32 m0, s27, 101376
    s_add_u32 s74, s83, 16384
    buffer_load_dwordx4 v6, s[28:31], s74 offen lds
    s_add_u32 m0, s3, 114688
    s_add_u32 s74, s76, 0
    buffer_load_dwordx4 v7, s[32:35], s74 offen lds
    s_add_u32 m0, s3, 118784
    s_add_u32 s74, s76, 1024
    buffer_load_dwordx4 v7, s[32:35], s74 offen lds
    s_add_u32 m0, s3, 122880
    s_add_u32 s74, s76, 2048
    buffer_load_dwordx4 v7, s[32:35], s74 offen lds
    s_waitcnt vmcnt(8)
    s_barrier
    s_cmp_ge_u32 s70, 14
    s_cselect_b32 s26, 0x40000000, s26
    s_add_u32 s75, s82, 4
    s_and_b32 s75, s75, 7
    s_lshl_b32 s83, s75, 7
    s_add_u32 s83, s83, s26
    s_mul_i32 s76, s75, 229376
    s_add_u32 s76, s76, s81
    s_add_u32 m0, s3, 16384
    s_add_u32 s74, s76, 0
    buffer_load_dwordx4 v8, s[36:39], s74 offen lds
    s_add_u32 m0, s3, 20480
    s_add_u32 s74, s76, 64
    buffer_load_dwordx4 v8, s[36:39], s74 offen lds
    s_add_u32 m0, s3, 24576
    s_add_u32 s74, s76, 128
    buffer_load_dwordx4 v8, s[36:39], s74 offen lds
    s_add_u32 m0, s3, 28672
    s_add_u32 s74, s76, 192
    buffer_load_dwordx4 v8, s[36:39], s74 offen lds
    s_waitcnt vmcnt(4)
    s_barrier
    s_add_u32 s75, s82, 5
    s_and_b32 s75, s75, 7
    s_lshl_b32 s83, s75, 7
    s_add_u32 s83, s83, s26
    s_mul_i32 s76, s75, 229376
    s_add_u32 s76, s76, s81
    s_add_u32 m0, s3, 49152
    s_add_u32 s74, s76, 0
    buffer_load_dwordx4 v8, s[36:39], s74 offen lds
    s_add_u32 m0, s3, 53248
    s_add_u32 s74, s76, 64
    buffer_load_dwordx4 v8, s[36:39], s74 offen lds
    s_add_u32 m0, s3, 57344
    s_add_u32 s74, s76, 128
    buffer_load_dwordx4 v8, s[36:39], s74 offen lds
    s_add_u32 m0, s3, 61440
    s_add_u32 s74, s76, 192
    buffer_load_dwordx4 v8, s[36:39], s74 offen lds
    s_waitcnt vmcnt(4)
    s_barrier
    s_add_u32 s75, s82, 6
    s_and_b32 s75, s75, 7
    s_lshl_b32 s83, s75, 7
    s_add_u32 s83, s83, s26
    s_mul_i32 s76, s75, 229376
    s_add_u32 s76, s76, s81
    s_add_u32 m0, s3, 81920
    s_add_u32 s74, s76, 0
    buffer_load_dwordx4 v8, s[36:39], s74 offen lds
    s_add_u32 m0, s3, 86016
    s_add_u32 s74, s76, 64
    buffer_load_dwordx4 v8, s[36:39], s74 offen lds
    s_add_u32 m0, s3, 90112
    s_add_u32 s74, s76, 128
    buffer_load_dwordx4 v8, s[36:39], s74 offen lds
    s_add_u32 m0, s3, 94208
    s_add_u32 s74, s76, 192
    buffer_load_dwordx4 v8, s[36:39], s74 offen lds
    s_waitcnt vmcnt(4)
    s_barrier
    s_add_u32 s75, s82, 7
    s_and_b32 s75, s75, 7
    s_lshl_b32 s83, s75, 7
    s_add_u32 s83, s83, s26
    s_mul_i32 s76, s75, 229376
    s_add_u32 s76, s76, s81
    s_add_u32 m0, s3, 114688
    s_add_u32 s74, s76, 0
    buffer_load_dwordx4 v8, s[36:39], s74 offen lds
    s_add_u32 m0, s3, 118784
    s_add_u32 s74, s76, 64
    buffer_load_dwordx4 v8, s[36:39], s74 offen lds
    s_add_u32 m0, s3, 122880
    s_add_u32 s74, s76, 128
    buffer_load_dwordx4 v8, s[36:39], s74 offen lds
    s_add_u32 m0, s3, 126976
    s_add_u32 s74, s76, 192
    buffer_load_dwordx4 v8, s[36:39], s74 offen lds
    s_waitcnt vmcnt(4)
    s_barrier
    s_add_u32 s75, s82, 0
    s_and_b32 s75, s75, 7
    s_lshl_b32 s83, s75, 7
    s_add_u32 s83, s83, s26
    s_mul_i32 s76, s75, 229376
    s_add_u32 s76, s76, s81
    s_add_u32 m0, s27, 0
    s_add_u32 s74, s83, 0
    buffer_load_dwordx4 v5, s[28:31], s74 offen lds
    s_add_u32 m0, s27, 1024
    s_add_u32 s74, s83, 0
    buffer_load_dwordx4 v6, s[28:31], s74 offen lds
    s_add_u32 m0, s27, 2048
    s_add_u32 s74, s83, 16384
    buffer_load_dwordx4 v5, s[28:31], s74 offen lds
    s_add_u32 m0, s27, 3072
    s_add_u32 s74, s83, 16384
    buffer_load_dwordx4 v6, s[28:31], s74 offen lds
    s_add_u32 m0, s3, 16384
    s_add_u32 s74, s76, 0
    buffer_load_dwordx4 v8, s[36:39], s74 offen lds
    s_add_u32 m0, s3, 20480
    s_add_u32 s74, s76, 64
    buffer_load_dwordx4 v8, s[36:39], s74 offen lds
    s_add_u32 m0, s3, 24576
    s_add_u32 s74, s76, 128
    buffer_load_dwordx4 v8, s[36:39], s74 offen lds
    s_add_u32 m0, s3, 28672
    s_add_u32 s74, s76, 192
    buffer_load_dwordx4 v8, s[36:39], s74 offen lds
    s_waitcnt vmcnt(31)
    s_mov_b32 s75, 0
G_EPL:
    v_readfirstlane_b32 s78, v14
    v_readfirstlane_b32 s79, v15
    s_cmp_lg_u32 s78, 0
    s_cbranch_scc1 G_EPD
    s_sleep 4
    buffer_load_dwordx2 v[14:15], off, s[64:67], 0 sc1
    s_waitcnt vmcnt(0)
    s_add_u32 s75, s75, 1
    s_cmp_lt_u32 s75, 200000
    s_cbranch_scc1 G_EPL
G_EPD:
    s_waitcnt vmcnt(8)
    s_barrier
    s_add_u32 s75, s82, 1
    s_and_b32 s75, s75, 7
    s_lshl_b32 s83, s75, 7
    s_add_u32 s83, s83, s26
    s_mul_i32 s76, s75, 229376
    s_add_u32 s76, s76, s81
    s_add_u32 m0, s27, 32768
    s_add_u32 s74, s83, 0
    buffer_load_dwordx4 v5, s[28:31], s74 offen lds
    s_add_u32 m0, s27, 33792
    s_add_u32 s74, s83, 0
    buffer_load_dwordx4 v6, s[28:31], s74 offen lds
    s_add_u32 m0, s27, 34816
    s_add_u32 s74, s83, 16384
    buffer_load_dwordx4 v5, s[28:31], s74 offen lds
    s_add_u32 m0, s27, 35840
    s_add_u32 s74, s83, 16384
    buffer_load_dwordx4 v6, s[28:31], s74 offen lds
    s_add_u32 m0, s3, 49152
    s_add_u32 s74, s76, 0
    buffer_load_dwordx4 v8, s[36:39], s74 offen lds
    s_add_u32 m0, s3, 53248
    s_add_u32 s74, s76, 64
    buffer_load_dwordx4 v8, s[36:39], s74 offen lds
    s_add_u32 m0, s3, 57344
    s_add_u32 s74, s76, 128
    buffer_load_dwordx4 v8, s[36:39], s74 offen lds
    s_add_u32 m0, s3, 61440
    s_add_u32 s74, s76, 192
    buffer_load_dwordx4 v8, s[36:39], s74 offen lds
    s_waitcnt vmcnt(8)
    s_barrier
    s_add_u32 s75, s82, 2
    s_and_b32 s75, s75, 7
    s_lshl_b32 s83, s75, 7
    s_add_u32 s83, s83, s26
    s_mul_i32 s76, s75, 229376
    s_add_u32 s76, s76, s81
    s_add_u32 m0, s27, 65536
    s_add_u32 s74, s83, 0
    buffer_load_dwordx4 v5, s[28:31], s74 offen lds
    s_add_u32 m0, s27, 66560
    s_add_u32 s74, s83, 0
    buffer_load_dwordx4 v6, s[28:31], s74 offen lds
    s_add_u32 m0, s27, 67584
    s_add_u32 s74, s83, 16384
    buffer_load_dwordx4 v5, s[28:31], s74 offen lds
    s_add_u32 m0, s27, 68608
    s_add_u32 s74, s83, 16384
    buffer_load_dwordx4 v6, s[28:31], s74 offen lds
    s_add_u32 m0, s3, 81920
    s_add_u32 s74, s76, 0
    buffer_load_dwordx4 v8, s[36:39], s74 offen lds
    s_add_u32 m0, s3, 86016
    s_add_u32 s74, s76, 64
    buffer_load_dwordx4 v8, s[36:39], s74 offen lds
    s_add_u32 m0, s3, 90112
    s_add_u32 s74, s76, 128
    buffer_load_dwordx4 v8, s[36:39], s74 offen lds
    s_add_u32 m0, s3, 94208
    s_add_u32 s74, s76, 192
    buffer_load_dwordx4 v8, s[36:39], s74 offen lds
    s_cmp_eq_u32 s71, 0
    s_cbranch_scc0 G_NOF1
    s_lshl_b32 s74, s70, 7
    s_lshl_b32 s75, s69, 3
    s_add_u32 s74, s74, s75
    s_add_u32 s74, s74, 0x1800000
    s_mov_b64 exec, 1
    buffer_store_dwordx2 v[14:15], off, s[40:43], s74 sc1
    s_mov_b64 exec, -1
G_NOF1:
    s_waitcnt vmcnt(8)
    s_barrier
    s_add_u32 s75, s82, 3
    s_and_b32 s75, s75, 7
    s_lshl_b32 s83, s75, 7
    s_add_u32 s83, s83, s26
    s_mul_i32 s76, s75, 229376
    s_add_u32 s76, s76, s81
    s_add_u32 m0, s27, 98304
    s_add_u32 s74, s83, 0
    buffer_load_dwordx4 v5, s[28:31], s74 offen lds
    s_add_u32 m0, s27, 99328
    s_add_u32 s74, s83, 0
    buffer_load_dwordx4 v6, s[28:31], s74 offen lds
    s_add_u32 m0, s27, 100352
    s_add_u32 s74, s83, 16384
    buffer_load_dwordx4 v5, s[28:31], s74 offen lds
    s_add_u32 m0, s27, 101376
    s_add_u32 s74, s83, 16384
    buffer_load_dwordx4 v6, s[28:31], s74 offen lds
    s_add_u32 m0, s3, 114688
    s_add_u32 s74, s76, 0
    buffer_load_dwordx4 v8, s[36:39], s74 offen lds
    s_add_u32 m0, s3, 118784
    s_add_u32 s74, s76, 64
    buffer_load_dwordx4 v8, s[36:39], s74 offen lds
    s_add_u32 m0, s3, 122880
    s_add_u32 s74, s76, 128
    buffer_load_dwordx4 v8, s[36:39], s74 offen lds
    s_add_u32 m0, s3, 126976
    s_add_u32 s74, s76, 192
    buffer_load_dwordx4 v8, s[36:39], s74 offen lds
    s_waitcnt vmcnt(8)
    s_barrier
    s_waitcnt vmcnt(0)
    s_barrier
    s_barrier
    s_and_b32 s74, s2, 7
    s_lshl_b32 s4, s74, 2
    s_bfe_u32 s74, s2, 0x20003
    s_add_u32 s4, s4, s74
    s_lshl_b32 s6, s71, 10
    s_lshl_b32 s5, s4, 17
    s_add_u32 s5, s5, 0x200000
    s_add_u32 s5, s5, s6
    s_lshr_b32 s74, s4, 1
    s_lshl_b32 s7, s74, 7
    s_add_u32 s7, s7, 0x1800000
    s_lshr_b32 s75, s2, 5
    s_lshl_b32 s9, s4, 16
    s_lshl_b32 s74, s75, 13
    s_add_u32 s9, s9, s74
    s_add_u32 s9, s9, s6
    s_add_u32 s9, s9, 0x0
    v_lshlrev_b32 v5, 3, v1
    v_and_b32 v6, 0x78, v5
    s_mov_b32 s75, 0
POLL_1:
    buffer_load_dwordx2 v[124:125], v6, s[40:43], s7 offen sc1
    s_waitcnt vmcnt(0)
    v_cmp_ne_u64 vcc, s[78:79], v[124:125]
    s_nop 1
    s_cmp_eq_u64 vcc, 0
    s_cbranch_scc1 POLLD_2
    s_sleep 4
    s_add_u32 s75, s75, 1
    s_cmp_lt_u32 s75, 200000
    s_cbranch_scc1 POLL_1
POLLD_2:
    s_add_u32 m0, s6, 131072
    s_add_u32 s74, s9, 0
    buffer_load_dwordx4 v2, s[40:43], s74 offen sc1 lds
    s_add_u32 m0, s6, 135168
    s_add_u32 s74, s9, 4096
    buffer_load_dwordx4 v2, s[40:43], s74 offen sc1 lds
    s_add_u32 m0, s6, 0
    s_add_u32 s74, s5, 0
    buffer_load_dwordx4 v2, s[40:43], s74 offen sc1 lds
    s_add_u32 m0, s6, 4096
    s_add_u32 s74, s5, 4096
    buffer_load_dwordx4 v2, s[40:43], s74 offen sc1 lds
    s_add_u32 m0, s6, 8192
    s_add_u32 s74, s5, 8192
    buffer_load_dwordx4 v2, s[40:43], s74 offen sc1 lds
    s_add_u32 m0, s6, 12288
    s_add_u32 s74, s5, 12288
    buffer_load_dwordx4 v2, s[40:43], s74 offen sc1 lds
    s_add_u32 m0, s6, 16384
    s_add_u32 s74, s5, 16384
    buffer_load_dwordx4 v2, s[40:43], s74 offen sc1 lds
    s_add_u32 m0, s6, 20480
    s_add_u32 s74, s5, 20480
    buffer_load_dwordx4 v2, s[40:43], s74 offen sc1 lds
    s_add_u32 m0, s6, 24576
    s_add_u32 s74, s5, 24576
    buffer_load_dwordx4 v2, s[40:43], s74 offen sc1 lds
    s_add_u32 m0, s6, 28672
    s_add_u32 s74, s5, 28672
    buffer_load_dwordx4 v2, s[40:43], s74 offen sc1 lds
    s_waitcnt vmcnt(4)
    s_barrier
    s_add_u32 m0, s6, 32768
    s_add_u32 s74, s5, 32768
    buffer_load_dwordx4 v2, s[40:43], s74 offen sc1 lds
    s_add_u32 m0, s6, 36864
    s_add_u32 s74, s5, 36864
    buffer_load_dwordx4 v2, s[40:43], s74 offen sc1 lds
    s_add_u32 m0, s6, 40960
    s_add_u32 s74, s5, 40960
    buffer_load_dwordx4 v2, s[40:43], s74 offen sc1 lds
    s_add_u32 m0, s6, 45056
    s_add_u32 s74, s5, 45056
    buffer_load_dwordx4 v2, s[40:43], s74 offen sc1 lds
    s_add_u32 m0, s6, 49152
    s_add_u32 s74, s5, 49152
    buffer_load_dwordx4 v2, s[40:43], s74 offen sc1 lds
    s_add_u32 m0, s6, 53248
    s_add_u32 s74, s5, 53248
    buffer_load_dwordx4 v2, s[40:43], s74 offen sc1 lds
    s_add_u32 m0, s6, 57344
    s_add_u32 s74, s5, 57344
    buffer_load_dwordx4 v2, s[40:43], s74 offen sc1 lds
    s_add_u32 m0, s6, 61440
    s_add_u32 s74, s5, 61440
    buffer_load_dwordx4 v2, s[40:43], s74 offen sc1 lds
    s_add_u32 m0, s6, 65536
    s_add_u32 s74, s5, 65536
    buffer_load_dwordx4 v2, s[40:43], s74 offen sc1 lds
    s_add_u32 m0, s6, 69632
    s_add_u32 s74, s5, 69632
    buffer_load_dwordx4 v2, s[40:43], s74 offen sc1 lds
    s_add_u32 m0, s6, 73728
    s_add_u32 s74, s5, 73728
    buffer_load_dwordx4 v2, s[40:43], s74 offen sc1 lds
    s_add_u32 m0, s6, 77824
    s_add_u32 s74, s5, 77824
    buffer_load_dwordx4 v2, s[40:43], s74 offen sc1 lds
    s_waitcnt vmcnt(12)
    s_barrier
    s_cmp_eq_u32 s71, 0
    s_cbranch_scc0 G_NOF2
    s_lshl_b32 s74, s69, 7
    s_lshl_b32 s75, s70, 3
    s_add_u32 s74, s74, s75
    s_add_u32 s74, s74, 0x1804000
    s_lshr_b32 s75, s2, 5
    s_lshl_b32 s75, s75, 8
    s_lshl_b32 s76, s4, 3
    s_add_u32 s75, s75, s76
    s_add_u32 s75, s75, 0x1808000
    s_mov_b64 exec, 1
    buffer_store_dwordx2 v[14:15], off, s[40:43], s74 sc1
    buffer_store_dwordx2 v[14:15], off, s[40:43], s75 sc1
    s_mov_b64 exec, -1
G_NOF2:
    s_add_u32 m0, s6, 81920
    s_add_u32 s74, s5, 81920
    buffer_load_dwordx4 v2, s[40:43], s74 offen sc1 lds
    s_add_u32 m0, s6, 86016
    s_add_u32 s74, s5, 86016
    buffer_load_dwordx4 v2, s[40:43], s74 offen sc1 lds
    s_add_u32 m0, s6, 90112
    s_add_u32 s74, s5, 90112
    buffer_load_dwordx4 v2, s[40:43], s74 offen sc1 lds
    s_add_u32 m0, s6, 94208
    s_add_u32 s74, s5, 94208
    buffer_load_dwordx4 v2, s[40:43], s74 offen sc1 lds
    s_add_u32 m0, s6, 98304
    s_add_u32 s74, s5, 98304
    buffer_load_dwordx4 v2, s[40:43], s74 offen sc1 lds
    s_add_u32 m0, s6, 102400
    s_add_u32 s74, s5, 102400
    buffer_load_dwordx4 v2, s[40:43], s74 offen sc1 lds
    s_add_u32 m0, s6, 106496
    s_add_u32 s74, s5, 106496
    buffer_load_dwordx4 v2, s[40:43], s74 offen sc1 lds
    s_add_u32 m0, s6, 110592
    s_add_u32 s74, s5, 110592
    buffer_load_dwordx4 v2, s[40:43], s74 offen sc1 lds
    s_add_u32 m0, s6, 114688
    s_add_u32 s74, s5, 114688
    buffer_load_dwordx4 v2, s[40:43], s74 offen sc1 lds
    s_add_u32 m0, s6, 118784
    s_add_u32 s74, s5, 118784
    buffer_load_dwordx4 v2, s[40:43], s74 offen sc1 lds
    s_add_u32 m0, s6, 122880
    s_add_u32 s74, s5, 122880
    buffer_load_dwordx4 v2, s[40:43], s74 offen sc1 lds
    s_add_u32 m0, s6, 126976
    s_add_u32 s74, s5, 126976
    buffer_load_dwordx4 v2, s[40:43], s74 offen sc1 lds
    s_and_b32 s74, s2, 7
    s_lshr_b32 s75, s2, 3
    s_lshr_b32 s17, s74, 1
    s_lshl_b32 s17, s17, 3
    s_and_b32 s77, s75, 7
    s_add_u32 s17, s17, s77
    s_and_b32 s18, s74, 1
    s_lshl_b32 s18, s18, 2
    s_lshr_b32 s75, s75, 3
    s_add_u32 s18, s18, s75
    s_lshr_b32 s75, s71, 1
    s_lshl_b32 s13, s17, 1
    s_add_u32 s13, s13, s75
    s_and_b32 s75, s71, 1
    s_lshl_b32 s14, s18, 1
    s_add_u32 s14, s14, s75
    s_mul_i32 s77, s71, 28672
    s_mul_i32 s10, s13, 114688
    s_add_u32 s10, s10, s77
    s_add_u32 s10, s10, 0x600000
    s_xor_b32 s75, s13, 1
    s_mul_i32 s11, s75, 114688
    s_add_u32 s11, s11, s77
    s_add_u32 s11, s11, 0x600000
    s_mul_i32 s12, s71, 458752
    s_lshl_b32 s75, s18, 7
    s_add_u32 s12, s12, s75
    s_lshl_b32 s16, s71, 13
    s_add_u32 s16, s16, 131072
    v_lshrrev_b32 v3, 3, v1
    v_bfe_u32 v4, v1, 4, 1
    v_lshlrev_b32 v4, 2, v4
    v_and_b32 v7, 7, v1
    v_xor_b32 v7, v7, v4
    v_lshlrev_b32 v7, 4, v7
    v_lshl_add_u32 v7, v3, 10, v7
    v_bfe_u32 v3, v1, 2, 2
    v_lshrrev_b32 v4, 5, v1
    v_lshl_add_u32 v3, v4, 2, v3
    v_lshlrev_b32 v122, 7, v3
    v_bfe_u32 v3, v1, 3, 1
    v_lshl_add_u32 v122, v3, 6, v122
    v_and_b32 v3, 1, v1
    v_lshl_add_u32 v122, v3, 5, v122
    v_bfe_u32 v3, v1, 4, 1
    v_lshl_add_u32 v122, v3, 4, v122
    v_bfe_u32 v3, v1, 1, 1
    v_lshl_add_u32 v122, v3, 3, v122
    s_and_b32 s75, s71, 1
    s_lshl_b32 s75, s75, 6
    v_xor_b32 v122, s75, v122
    v_add_u32 v122, s16, v122
    v_xor_b32 v123, 64, v122
    s_lshr_b32 s8, s17, 2
    s_lshl_b32 s8, s8, 8
    s_add_u32 s8, s8, 0x1808000
    v_and_b32 v5, 0xf8, v5
    s_lshr_b32 s7, s17, 1
    s_lshl_b32 s7, s7, 7
    s_add_u32 s7, s7, 0x1804000
    s_waitcnt vmcnt(0)
    s_barrier
    s_setprio 0
    s_mov_b32 s75, 0
POLL_3:
    buffer_load_dwordx2 v[124:125], v6, s[40:43], s7 offen sc1
    s_waitcnt vmcnt(0)
    v_cmp_ne_u64 vcc, s[78:79], v[124:125]
    s_nop 1
    s_cmp_eq_u64 vcc, 0
    s_cbranch_scc1 POLLD_4
    s_sleep 4
    s_add_u32 s75, s75, 1
    s_cmp_lt_u32 s75, 200000
    s_cbranch_scc1 POLL_3
POLLD_4:
    v_and_b32 v3, 31, v1
    v_lshlrev_b32 v3, 2, v3
    s_lshl_b32 s74, s13, 7
    s_add_u32 s74, s74, 0xf40000
    s_xor_b32 s75, s74, 128
    buffer_load_dword v120, v3, s[40:43], s74 offen sc1
    buffer_load_dword v121, v3, s[40:43], s75 offen sc1
    s_add_u32 m0, s16, 0
    s_add_u32 s74, s12, 8192
    buffer_load_dwordx4 v7, s[48:51], s12 offen lds
    s_add_u32 m0, s16, 1024
    s_add_u32 s12, s12, 16384
    buffer_load_dwordx4 v7, s[48:51], s74 offen lds
    buffer_load_dwordx4 v[72:75], v2, s[40:43], s10 offen offset:0 sc1
    buffer_load_dwordx4 v[76:79], v2, s[40:43], s11 offen offset:0 sc1
    s_add_u32 m0, s16, 2048
    s_add_u32 s74, s12, 8192
    buffer_load_dwordx4 v7, s[48:51], s12 offen lds
    s_add_u32 m0, s16, 3072
    s_add_u32 s12, s12, 16384
    buffer_load_dwordx4 v7, s[48:51], s74 offen lds
    buffer_load_dwordx4 v[80:83], v2, s[40:43], s10 offen offset:1024 sc1
    buffer_load_dwordx4 v[84:87], v2, s[40:43], s11 offen offset:1024 sc1
    s_add_u32 m0, s16, 4096
    s_add_u32 s74, s12, 8192
    buffer_load_dwordx4 v7, s[48:51], s12 offen lds
    s_add_u32 m0, s16, 5120
    s_add_u32 s12, s12, 16384
    buffer_load_dwordx4 v7, s[48:51], s74 offen lds
    buffer_load_dwordx4 v[88:91], v2, s[40:43], s10 offen offset:2048 sc1
    buffer_load_dwordx4 v[92:95], v2, s[40:43], s11 offen offset:2048 sc1
    s_add_u32 m0, s16, 6144
    s_add_u32 s74, s12, 8192
    buffer_load_dwordx4 v7, s[48:51], s12 offen lds
    s_add_u32 m0, s16, 7168
    s_add_u32 s12, s12, 16384
    buffer_load_dwordx4 v7, s[48:51], s74 offen lds
    buffer_load_dwordx4 v[96:99], v2, s[40:43], s10 offen offset:3072 sc1
    buffer_load_dwordx4 v[100:103], v2, s[40:43], s11 offen offset:3072 sc1
    s_add_u32 s10, s10, 4096
    s_add_u32 s11, s11, 4096
    s_waitcnt vmcnt(12)
    ds_read_b64_tr_b16 v[104:105], v122 offset:0
    ds_read_b64_tr_b16 v[106:107], v122 offset:1024
    ds_read_b64_tr_b16 v[108:109], v123 offset:0
    ds_read_b64_tr_b16 v[110:111], v123 offset:1024
    s_waitcnt lgkmcnt(0)
    v_mfma_f32_32x32x16_bf16 v[8:23], v[104:107], v[72:75], 0
    v_mfma_f32_32x32x16_bf16 v[24:39], v[108:111], v[72:75], 0
    v_mfma_f32_32x32x16_bf16 v[40:55], v[104:107], v[76:79], 0
    v_mfma_f32_32x32x16_bf16 v[56:71], v[108:111], v[76:79], 0
    s_add_u32 m0, s16, 0
    s_add_u32 s74, s12, 8192
    buffer_load_dwordx4 v7, s[48:51], s12 offen lds
    s_add_u32 m0, s16, 1024
    s_add_u32 s12, s12, 16384
    buffer_load_dwordx4 v7, s[48:51], s74 offen lds
    buffer_load_dwordx4 v[72:75], v2, s[40:43], s10 offen offset:0 sc1
    buffer_load_dwordx4 v[76:79], v2, s[40:43], s11 offen offset:0 sc1
    s_waitcnt vmcnt(12)
    ds_read_b64_tr_b16 v[112:113], v122 offset:2048
    ds_read_b64_tr_b16 v[114:115], v122 offset:3072
    ds_read_b64_tr_b16 v[116:117], v123 offset:2048
    ds_read_b64_tr_b16 v[118:119], v123 offset:3072
    s_waitcnt lgkmcnt(0)
    v_mfma_f32_32x32x16_bf16 v[8:23], v[112:115], v[80:83], v[8:23]
    v_mfma_f32_32x32x16_bf16 v[24:39], v[116:119], v[80:83], v[24:39]
    v_mfma_f32_32x32x16_bf16 v[40:55], v[112:115], v[84:87], v[40:55]
    v_mfma_f32_32x32x16_bf16 v[56:71], v[116:119], v[84:87], v[56:71]
    s_add_u32 m0, s16, 2048
    s_add_u32 s74, s12, 8192
    buffer_load_dwordx4 v7, s[48:51], s12 offen lds
    s_add_u32 m0, s16, 3072
    s_add_u32 s12, s12, 16384
    buffer_load_dwordx4 v7, s[48:51], s74 offen lds
    buffer_load_dwordx4 v[80:83], v2, s[40:43], s10 offen offset:1024 sc1
    buffer_load_dwordx4 v[84:87], v2, s[40:43], s11 offen offset:1024 sc1
    s_waitcnt vmcnt(12)
    ds_read_b64_tr_b16 v[104:105], v122 offset:4096
    ds_read_b64_tr_b16 v[106:107], v122 offset:5120
    ds_read_b64_tr_b16 v[108:109], v123 offset:4096
    ds_read_b64_tr_b16 v[110:111], v123 offset:5120
    s_waitcnt lgkmcnt(0)
    v_mfma_f32_32x32x16_bf16 v[8:23], v[104:107], v[88:91], v[8:23]
    v_mfma_f32_32x32x16_bf16 v[24:39], v[108:111], v[88:91], v[24:39]
    v_mfma_f32_32x32x16_bf16 v[40:55], v[104:107], v[92:95], v[40:55]
    v_mfma_f32_32x32x16_bf16 v[56:71], v[108:111], v[92:95], v[56:71]
    s_add_u32 m0, s16, 4096
    s_add_u32 s74, s12, 8192
    buffer_load_dwordx4 v7, s[48:51], s12 offen lds
    s_add_u32 m0, s16, 5120
    s_add_u32 s12, s12, 16384
    buffer_load_dwordx4 v7, s[48:51], s74 offen lds
    buffer_load_dwordx4 v[88:91], v2, s[40:43], s10 offen offset:2048 sc1
    buffer_load_dwordx4 v[92:95], v2, s[40:43], s11 offen offset:2048 sc1
    s_waitcnt vmcnt(12)
    ds_read_b64_tr_b16 v[112:113], v122 offset:6144
    ds_read_b64_tr_b16 v[114:115], v122 offset:7168
    ds_read_b64_tr_b16 v[116:117], v123 offset:6144
    ds_read_b64_tr_b16 v[118:119], v123 offset:7168
    s_waitcnt lgkmcnt(0)
    v_mfma_f32_32x32x16_bf16 v[8:23], v[112:115], v[96:99], v[8:23]
    v_mfma_f32_32x32x16_bf16 v[24:39], v[116:119], v[96:99], v[24:39]
    v_mfma_f32_32x32x16_bf16 v[40:55], v[112:115], v[100:103], v[40:55]
    v_mfma_f32_32x32x16_bf16 v[56:71], v[116:119], v[100:103], v[56:71]
    s_add_u32 m0, s16, 6144
    s_add_u32 s74, s12, 8192
    buffer_load_dwordx4 v7, s[48:51], s12 offen lds
    s_add_u32 m0, s16, 7168
    s_add_u32 s12, s12, 16384
    buffer_load_dwordx4 v7, s[48:51], s74 offen lds
    buffer_load_dwordx4 v[96:99], v2, s[40:43], s10 offen offset:3072 sc1
    buffer_load_dwordx4 v[100:103], v2, s[40:43], s11 offen offset:3072 sc1
    s_add_u32 s10, s10, 4096
    s_add_u32 s11, s11, 4096
    s_mov_b32 s15, 0
G_LOOP:
    s_waitcnt vmcnt(12)
    ds_read_b64_tr_b16 v[104:105], v122 offset:0
    ds_read_b64_tr_b16 v[106:107], v122 offset:1024
    ds_read_b64_tr_b16 v[108:109], v123 offset:0
    ds_read_b64_tr_b16 v[110:111], v123 offset:1024
    s_waitcnt lgkmcnt(0)
    v_mfma_f32_32x32x16_bf16 v[8:23], v[104:107], v[72:75], v[8:23]
    v_mfma_f32_32x32x16_bf16 v[24:39], v[108:111], v[72:75], v[24:39]
    v_mfma_f32_32x32x16_bf16 v[40:55], v[104:107], v[76:79], v[40:55]
    v_mfma_f32_32x32x16_bf16 v[56:71], v[108:111], v[76:79], v[56:71]
    s_add_u32 m0, s16, 0
    s_add_u32 s74, s12, 8192
    buffer_load_dwordx4 v7, s[48:51], s12 offen lds
    s_add_u32 m0, s16, 1024
    s_add_u32 s12, s12, 16384
    buffer_load_dwordx4 v7, s[48:51], s74 offen lds
    buffer_load_dwordx4 v[72:75], v2, s[40:43], s10 offen offset:0 sc1
    buffer_load_dwordx4 v[76:79], v2, s[40:43], s11 offen offset:0 sc1
    s_waitcnt vmcnt(12)
    ds_read_b64_tr_b16 v[112:113], v122 offset:2048
    ds_read_b64_tr_b16 v[114:115], v122 offset:3072
    ds_read_b64_tr_b16 v[116:117], v123 offset:2048
    ds_read_b64_tr_b16 v[118:119], v123 offset:3072
    s_waitcnt lgkmcnt(0)
    v_mfma_f32_32x32x16_bf16 v[8:23], v[112:115], v[80:83], v[8:23]
    v_mfma_f32_32x32x16_bf16 v[24:39], v[116:119], v[80:83], v[24:39]
    v_mfma_f32_32x32x16_bf16 v[40:55], v[112:115], v[84:87], v[40:55]
    v_mfma_f32_32x32x16_bf16 v[56:71], v[116:119], v[84:87], v[56:71]
    s_add_u32 m0, s16, 2048
    s_add_u32 s74, s12, 8192
    buffer_load_dwordx4 v7, s[48:51], s12 offen lds
    s_add_u32 m0, s16, 3072
    s_add_u32 s12, s12, 16384
    buffer_load_dwordx4 v7, s[48:51], s74 offen lds
    buffer_load_dwordx4 v[80:83], v2, s[40:43], s10 offen offset:1024 sc1
    buffer_load_dwordx4 v[84:87], v2, s[40:43], s11 offen offset:1024 sc1
    s_waitcnt vmcnt(12)
    ds_read_b64_tr_b16 v[104:105], v122 offset:4096
    ds_read_b64_tr_b16 v[106:107], v122 offset:5120
    ds_read_b64_tr_b16 v[108:109], v123 offset:4096
    ds_read_b64_tr_b16 v[110:111], v123 offset:5120
    s_waitcnt lgkmcnt(0)
    v_mfma_f32_32x32x16_bf16 v[8:23], v[104:107], v[88:91], v[8:23]
    v_mfma_f32_32x32x16_bf16 v[24:39], v[108:111], v[88:91], v[24:39]
    v_mfma_f32_32x32x16_bf16 v[40:55], v[104:107], v[92:95], v[40:55]
    v_mfma_f32_32x32x16_bf16 v[56:71], v[108:111], v[92:95], v[56:71]
    s_add_u32 m0, s16, 4096
    s_add_u32 s74, s12, 8192
    buffer_load_dwordx4 v7, s[48:51], s12 offen lds
    s_add_u32 m0, s16, 5120
    s_add_u32 s12, s12, 16384
    buffer_load_dwordx4 v7, s[48:51], s74 offen lds
    buffer_load_dwordx4 v[88:91], v2, s[40:43], s10 offen offset:2048 sc1
    buffer_load_dwordx4 v[92:95], v2, s[40:43], s11 offen offset:2048 sc1
    s_waitcnt vmcnt(12)
    ds_read_b64_tr_b16 v[112:113], v122 offset:6144
    ds_read_b64_tr_b16 v[114:115], v122 offset:7168
    ds_read_b64_tr_b16 v[116:117], v123 offset:6144
    ds_read_b64_tr_b16 v[118:119], v123 offset:7168
    s_waitcnt lgkmcnt(0)
    v_mfma_f32_32x32x16_bf16 v[8:23], v[112:115], v[96:99], v[8:23]
    v_mfma_f32_32x32x16_bf16 v[24:39], v[116:119], v[96:99], v[24:39]
    v_mfma_f32_32x32x16_bf16 v[40:55], v[112:115], v[100:103], v[40:55]
    v_mfma_f32_32x32x16_bf16 v[56:71], v[116:119], v[100:103], v[56:71]
    s_add_u32 m0, s16, 6144
    s_add_u32 s74, s12, 8192
    buffer_load_dwordx4 v7, s[48:51], s12 offen lds
    s_add_u32 m0, s16, 7168
    s_add_u32 s12, s12, 16384
    buffer_load_dwordx4 v7, s[48:51], s74 offen lds
    buffer_load_dwordx4 v[96:99], v2, s[40:43], s10 offen offset:3072 sc1
    buffer_load_dwordx4 v[100:103], v2, s[40:43], s11 offen offset:3072 sc1
    s_add_u32 s10, s10, 4096
    s_add_u32 s11, s11, 4096
    s_add_u32 s15, s15, 1
    s_cmp_lt_u32 s15, 5
    s_cbranch_scc1 G_LOOP
    s_waitcnt vmcnt(12)
    ds_read_b64_tr_b16 v[104:105], v122 offset:0
    ds_read_b64_tr_b16 v[106:107], v122 offset:1024
    ds_read_b64_tr_b16 v[108:109], v123 offset:0
    ds_read_b64_tr_b16 v[110:111], v123 offset:1024
    s_waitcnt lgkmcnt(0)
    v_mfma_f32_32x32x16_bf16 v[8:23], v[104:107], v[72:75], v[8:23]
    v_mfma_f32_32x32x16_bf16 v[24:39], v[108:111], v[72:75], v[24:39]
    v_mfma_f32_32x32x16_bf16 v[40:55], v[104:107], v[76:79], v[40:55]
    v_mfma_f32_32x32x16_bf16 v[56:71], v[108:111], v[76:79], v[56:71]
    s_waitcnt vmcnt(8)
    ds_read_b64_tr_b16 v[112:113], v122 offset:2048
    ds_read_b64_tr_b16 v[114:115], v122 offset:3072
    ds_read_b64_tr_b16 v[116:117], v123 offset:2048
    ds_read_b64_tr_b16 v[118:119], v123 offset:3072
    s_waitcnt lgkmcnt(0)
    v_mfma_f32_32x32x16_bf16 v[8:23], v[112:115], v[80:83], v[8:23]
    v_mfma_f32_32x32x16_bf16 v[24:39], v[116:119], v[80:83], v[24:39]
    v_mfma_f32_32x32x16_bf16 v[40:55], v[112:115], v[84:87], v[40:55]
    v_mfma_f32_32x32x16_bf16 v[56:71], v[116:119], v[84:87], v[56:71]
    s_waitcnt vmcnt(4)
    ds_read_b64_tr_b16 v[104:105], v122 offset:4096
    ds_read_b64_tr_b16 v[106:107], v122 offset:5120
    ds_read_b64_tr_b16 v[108:109], v123 offset:4096
    ds_read_b64_tr_b16 v[110:111], v123 offset:5120
    s_waitcnt lgkmcnt(0)
    v_mfma_f32_32x32x16_bf16 v[8:23], v[104:107], v[88:91], v[8:23]
    v_mfma_f32_32x32x16_bf16 v[24:39], v[108:111], v[88:91], v[24:39]
    v_mfma_f32_32x32x16_bf16 v[40:55], v[104:107], v[92:95], v[40:55]
    v_mfma_f32_32x32x16_bf16 v[56:71], v[108:111], v[92:95], v[56:71]
    s_waitcnt vmcnt(0)
    ds_read_b64_tr_b16 v[112:113], v122 offset:6144
    ds_read_b64_tr_b16 v[114:115], v122 offset:7168
    ds_read_b64_tr_b16 v[116:117], v123 offset:6144
    ds_read_b64_tr_b16 v[118:119], v123 offset:7168
    s_waitcnt lgkmcnt(0)
    v_mfma_f32_32x32x16_bf16 v[8:23], v[112:115], v[96:99], v[8:23]
    v_mfma_f32_32x32x16_bf16 v[24:39], v[116:119], v[96:99], v[24:39]
    v_mfma_f32_32x32x16_bf16 v[40:55], v[112:115], v[100:103], v[40:55]
    v_mfma_f32_32x32x16_bf16 v[56:71], v[116:119], v[100:103], v[56:71]
    s_lshl_b32 s12, s71, 17
    s_lshl_b32 s75, s18, 7
    s_add_u32 s12, s12, s75
    s_add_u32 m0, s16, 0
    s_add_u32 s74, s12, 8192
    buffer_load_dwordx4 v7, s[52:55], s12 offen lds
    s_add_u32 m0, s16, 1024
    s_add_u32 s12, s12, 16384
    buffer_load_dwordx4 v7, s[52:55], s74 offen lds
    s_add_u32 m0, s16, 2048
    s_add_u32 s74, s12, 8192
    buffer_load_dwordx4 v7, s[52:55], s12 offen lds
    s_add_u32 m0, s16, 3072
    s_add_u32 s12, s12, 16384
    buffer_load_dwordx4 v7, s[52:55], s74 offen lds
    s_add_u32 m0, s16, 4096
    s_add_u32 s74, s12, 8192
    buffer_load_dwordx4 v7, s[52:55], s12 offen lds
    s_add_u32 m0, s16, 5120
    s_add_u32 s12, s12, 16384
    buffer_load_dwordx4 v7, s[52:55], s74 offen lds
    s_add_u32 m0, s16, 6144
    s_add_u32 s74, s12, 8192
    buffer_load_dwordx4 v7, s[52:55], s12 offen lds
    s_add_u32 m0, s16, 7168
    s_add_u32 s12, s12, 16384
    buffer_load_dwordx4 v7, s[52:55], s74 offen lds
    v_sub_f32 v3, 1.0, v120
    v_sub_f32 v4, 1.0, v121
    v_mov_b32 v152, v122
    v_mov_b32 v153, v123
    s_nop 7
    v_mul_f32 v8, v8, v3
    v_mul_f32 v9, v9, v3
    v_mul_f32 v10, v10, v3
    v_mul_f32 v11, v11, v3
    v_mul_f32 v12, v12, v3
    v_mul_f32 v13, v13, v3
    v_mul_f32 v14, v14, v3
    v_mul_f32 v15, v15, v3
    v_mul_f32 v16, v16, v3
    v_mul_f32 v17, v17, v3
    v_mul_f32 v18, v18, v3
    v_mul_f32 v19, v19, v3
    v_mul_f32 v20, v20, v3
    v_mul_f32 v21, v21, v3
    v_mul_f32 v22, v22, v3
    v_mul_f32 v23, v23, v3
    v_mul_f32 v24, v24, v3
    v_mul_f32 v25, v25, v3
    v_mul_f32 v26, v26, v3
    v_mul_f32 v27, v27, v3
    v_mul_f32 v28, v28, v3
    v_mul_f32 v29, v29, v3
    v_mul_f32 v30, v30, v3
    v_mul_f32 v31, v31, v3
    v_mul_f32 v32, v32, v3
    v_mul_f32 v33, v33, v3
    v_mul_f32 v34, v34, v3
    v_mul_f32 v35, v35, v3
    v_mul_f32 v36, v36, v3
    v_mul_f32 v37, v37, v3
    v_mul_f32 v38, v38, v3
    v_mul_f32 v39, v39, v3
    v_mul_f32 v40, v40, v4
    v_mul_f32 v41, v41, v4
    v_mul_f32 v42, v42, v4
    v_mul_f32 v43, v43, v4
    v_mul_f32 v44, v44, v4
    v_mul_f32 v45, v45, v4
    v_mul_f32 v46, v46, v4
    v_mul_f32 v47, v47, v4
    v_mul_f32 v48, v48, v4
    v_mul_f32 v49, v49, v4
    v_mul_f32 v50, v50, v4
    v_mul_f32 v51, v51, v4
    v_mul_f32 v52, v52, v4
    v_mul_f32 v53, v53, v4
    v_mul_f32 v54, v54, v4
    v_mul_f32 v55, v55, v4
    v_mul_f32 v56, v56, v4
    v_mul_f32 v57, v57, v4
    v_mul_f32 v58, v58, v4
    v_mul_f32 v59, v59, v4
    v_mul_f32 v60, v60, v4
    v_mul_f32 v61, v61, v4
    v_mul_f32 v62, v62, v4
    v_mul_f32 v63, v63, v4
    v_mul_f32 v64, v64, v4
    v_mul_f32 v65, v65, v4
    v_mul_f32 v66, v66, v4
    v_mul_f32 v67, v67, v4
    v_mul_f32 v68, v68, v4
    v_mul_f32 v69, v69, v4
    v_mul_f32 v70, v70, v4
    v_mul_f32 v71, v71, v4
    s_waitcnt vmcnt(6)
    ds_read_b64_tr_b16 v[72:73], v152 offset:0
    ds_read_b64_tr_b16 v[74:75], v152 offset:1024
    ds_read_b64_tr_b16 v[76:77], v153 offset:0
    ds_read_b64_tr_b16 v[78:79], v153 offset:1024
    s_waitcnt lgkmcnt(0)
    s_add_u32 m0, s16, 0
    s_add_u32 s74, s12, 8192
    buffer_load_dwordx4 v7, s[52:55], s12 offen lds
    s_add_u32 m0, s16, 1024
    s_add_u32 s12, s12, 16384
    buffer_load_dwordx4 v7, s[52:55], s74 offen lds
    s_waitcnt vmcnt(6)
    ds_read_b64_tr_b16 v[80:81], v152 offset:2048
    ds_read_b64_tr_b16 v[82:83], v152 offset:3072
    ds_read_b64_tr_b16 v[84:85], v153 offset:2048
    ds_read_b64_tr_b16 v[86:87], v153 offset:3072
    s_waitcnt lgkmcnt(0)
    s_add_u32 m0, s16, 2048
    s_add_u32 s74, s12, 8192
    buffer_load_dwordx4 v7, s[52:55], s12 offen lds
    s_add_u32 m0, s16, 3072
    s_add_u32 s12, s12, 16384
    buffer_load_dwordx4 v7, s[52:55], s74 offen lds
    s_waitcnt vmcnt(6)
    ds_read_b64_tr_b16 v[88:89], v152 offset:4096
    ds_read_b64_tr_b16 v[90:91], v152 offset:5120
    ds_read_b64_tr_b16 v[92:93], v153 offset:4096
    ds_read_b64_tr_b16 v[94:95], v153 offset:5120
    s_waitcnt lgkmcnt(0)
    s_add_u32 m0, s16, 4096
    s_add_u32 s74, s12, 8192
    buffer_load_dwordx4 v7, s[52:55], s12 offen lds
    s_add_u32 m0, s16, 5120
    s_add_u32 s12, s12, 16384
    buffer_load_dwordx4 v7, s[52:55], s74 offen lds
    s_waitcnt vmcnt(6)
    ds_read_b64_tr_b16 v[96:97], v152 offset:6144
    ds_read_b64_tr_b16 v[98:99], v152 offset:7168
    ds_read_b64_tr_b16 v[100:101], v153 offset:6144
    ds_read_b64_tr_b16 v[102:103], v153 offset:7168
    s_waitcnt lgkmcnt(0)
    s_add_u32 m0, s16, 6144
    s_add_u32 s74, s12, 8192
    buffer_load_dwordx4 v7, s[52:55], s12 offen lds
    s_add_u32 m0, s16, 7168
    s_add_u32 s12, s12, 16384
    buffer_load_dwordx4 v7, s[52:55], s74 offen lds
    s_waitcnt vmcnt(6)
    ds_read_b64_tr_b16 v[104:105], v152 offset:0
    ds_read_b64_tr_b16 v[106:107], v152 offset:1024
    ds_read_b64_tr_b16 v[108:109], v153 offset:0
    ds_read_b64_tr_b16 v[110:111], v153 offset:1024
    s_waitcnt vmcnt(4)
    ds_read_b64_tr_b16 v[112:113], v152 offset:2048
    ds_read_b64_tr_b16 v[114:115], v152 offset:3072
    ds_read_b64_tr_b16 v[116:117], v153 offset:2048
    ds_read_b64_tr_b16 v[118:119], v153 offset:3072
    s_waitcnt vmcnt(2)
    ds_read_b64_tr_b16 v[120:121], v152 offset:4096
    ds_read_b64_tr_b16 v[122:123], v152 offset:5120
    ds_read_b64_tr_b16 v[124:125], v153 offset:4096
    ds_read_b64_tr_b16 v[126:127], v153 offset:5120
    s_waitcnt vmcnt(0)
    ds_read_b64_tr_b16 v[128:129], v152 offset:6144
    ds_read_b64_tr_b16 v[130:131], v152 offset:7168
    ds_read_b64_tr_b16 v[132:133], v153 offset:6144
    ds_read_b64_tr_b16 v[134:135], v153 offset:7168
    s_lshl_b32 s10, s13, 15
    s_lshl_b32 s77, s71, 13
    s_add_u32 s10, s10, s77
    s_add_u32 s10, s10, 0x1000000
    s_xor_b32 s11, s10, 32768
    s_lshl_b32 s6, s71, 14
    v_add_u32 v154, s6, v2
    s_mov_b32 s75, 0
POLL_5:
    buffer_load_dwordx2 v[156:157], v5, s[40:43], s8 offen sc1
    s_waitcnt vmcnt(0)
    v_cmp_ne_u64 vcc, s[78:79], v[156:157]
    s_nop 1
    s_cmp_eq_u64 vcc, 0
    s_cbranch_scc1 POLLD_6
    s_sleep 4
    s_add_u32 s75, s75, 1
    s_cmp_lt_u32 s75, 200000
    s_cbranch_scc1 POLL_5
POLLD_6:
    s_mov_b64 s[22:23], -1
    s_mov_b32 s19, 0
    s_waitcnt lgkmcnt(0)
    s_barrier
    s_setprio 3
    s_branch G_P3
G_RELOAD:
    s_add_u32 m0, s6, 0
    s_add_u32 s74, s10, 0
    buffer_load_dwordx4 v2, s[40:43], s74 offen sc1 lds
    s_add_u32 m0, s6, 1024
    s_add_u32 s74, s11, 0
    buffer_load_dwordx4 v2, s[40:43], s74 offen sc1 lds
    s_add_u32 m0, s6, 2048
    s_add_u32 s74, s10, 1024
    buffer_load_dwordx4 v2, s[40:43], s74 offen sc1 lds
    s_add_u32 m0, s6, 3072
    s_add_u32 s74, s11, 1024
    buffer_load_dwordx4 v2, s[40:43], s74 offen sc1 lds
    s_add_u32 m0, s6, 4096
    s_add_u32 s74, s10, 2048
    buffer_load_dwordx4 v2, s[40:43], s74 offen sc1 lds
    s_add_u32 m0, s6, 5120
    s_add_u32 s74, s11, 2048
    buffer_load_dwordx4 v2, s[40:43], s74 offen sc1 lds
    s_add_u32 m0, s6, 6144
    s_add_u32 s74, s10, 3072
    buffer_load_dwordx4 v2, s[40:43], s74 offen sc1 lds
    s_add_u32 m0, s6, 7168
    s_add_u32 s74, s11, 3072
    buffer_load_dwordx4 v2, s[40:43], s74 offen sc1 lds
    s_add_u32 m0, s6, 8192
    s_add_u32 s74, s10, 4096
    buffer_load_dwordx4 v2, s[40:43], s74 offen sc1 lds
    s_add_u32 m0, s6, 9216
    s_add_u32 s74, s11, 4096
    buffer_load_dwordx4 v2, s[40:43], s74 offen sc1 lds
    s_add_u32 m0, s6, 10240
    s_add_u32 s74, s10, 5120
    buffer_load_dwordx4 v2, s[40:43], s74 offen sc1 lds
    s_add_u32 m0, s6, 11264
    s_add_u32 s74, s11, 5120
    buffer_load_dwordx4 v2, s[40:43], s74 offen sc1 lds
    s_add_u32 m0, s6, 12288
    s_add_u32 s74, s10, 6144
    buffer_load_dwordx4 v2, s[40:43], s74 offen sc1 lds
    s_add_u32 m0, s6, 13312
    s_add_u32 s74, s11, 6144
    buffer_load_dwordx4 v2, s[40:43], s74 offen sc1 lds
    s_add_u32 m0, s6, 14336
    s_add_u32 s74, s10, 7168
    buffer_load_dwordx4 v2, s[40:43], s74 offen sc1 lds
    s_add_u32 m0, s6, 15360
    s_add_u32 s74, s11, 7168
    buffer_load_dwordx4 v2, s[40:43], s74 offen sc1 lds
    s_add_u32 s19, s19, 1
    s_cmp_lt_u32 s19, 200000
    s_cselect_b64 s[22:23], -1, 0
    s_setpc_b64 s[20:21]
G_P3:
    s_call_b64 s[20:21], G_RELOAD
    s_waitcnt vmcnt(14)
    ds_read_b128 v[136:139], v154 offset:0
    ds_read_b128 v[140:143], v154 offset:1024
G_V0:
    s_waitcnt lgkmcnt(0)
    v_max3_u32 v155, v136, v137, v138
    v_max3_u32 v155, v155, v139, v140
    v_max3_u32 v155, v155, v141, v142
    v_max_u32 v155, v155, v143
    v_cmp_eq_u32 vcc, -1, v155
    s_nop 1
    s_and_b64 vcc, vcc, s[22:23]
    s_cbranch_scc0 G_OK0
    s_call_b64 s[20:21], G_RELOAD
    s_waitcnt vmcnt(0)
    ds_read_b128 v[136:139], v154 offset:0
    ds_read_b128 v[140:143], v154 offset:1024
    s_branch G_V0
G_OK0:
    s_waitcnt vmcnt(12)
    ds_read_b128 v[144:147], v154 offset:2048
    ds_read_b128 v[148:151], v154 offset:3072
    v_mfma_f32_32x32x16_bf16 v[8:23], v[72:75], v[136:139], v[8:23]
    v_mfma_f32_32x32x16_bf16 v[24:39], v[76:79], v[136:139], v[24:39]
    v_mfma_f32_32x32x16_bf16 v[40:55], v[72:75], v[140:143], v[40:55]
    v_mfma_f32_32x32x16_bf16 v[56:71], v[76:79], v[140:143], v[56:71]
G_V1:
    s_waitcnt lgkmcnt(0)
    v_max3_u32 v155, v144, v145, v146
    v_max3_u32 v155, v155, v147, v148
    v_max3_u32 v155, v155, v149, v150
    v_max_u32 v155, v155, v151
    v_cmp_eq_u32 vcc, -1, v155
    s_nop 1
    s_and_b64 vcc, vcc, s[22:23]
    s_cbranch_scc0 G_OK1
    s_call_b64 s[20:21], G_RELOAD
    s_waitcnt vmcnt(0)
    ds_read_b128 v[144:147], v154 offset:2048
    ds_read_b128 v[148:151], v154 offset:3072
    s_branch G_V1
G_OK1:
    s_waitcnt vmcnt(10)
    ds_read_b128 v[136:139], v154 offset:4096
    ds_read_b128 v[140:143], v154 offset:5120
    v_mfma_f32_32x32x16_bf16 v[8:23], v[80:83], v[144:147], v[8:23]
    v_mfma_f32_32x32x16_bf16 v[24:39], v[84:87], v[144:147], v[24:39]
    v_mfma_f32_32x32x16_bf16 v[40:55], v[80:83], v[148:151], v[40:55]
    v_mfma_f32_32x32x16_bf16 v[56:71], v[84:87], v[148:151], v[56:71]
G_V2:
    s_waitcnt lgkmcnt(0)
    v_max3_u32 v155, v136, v137, v138
    v_max3_u32 v155, v155, v139, v140
    v_max3_u32 v155, v155, v141, v142
    v_max_u32 v155, v155, v143
    v_cmp_eq_u32 vcc, -1, v155
    s_nop 1
    s_and_b64 vcc, vcc, s[22:23]
    s_cbranch_scc0 G_OK2
    s_call_b64 s[20:21], G_RELOAD
    s_waitcnt vmcnt(0)
    ds_read_b128 v[136:139], v154 offset:4096
    ds_read_b128 v[140:143], v154 offset:5120
    s_branch G_V2
G_OK2:
    s_waitcnt vmcnt(8)
    ds_read_b128 v[144:147], v154 offset:6144
    ds_read_b128 v[148:151], v154 offset:7168
    v_mfma_f32_32x32x16_bf16 v[8:23], v[88:91], v[136:139], v[8:23]
    v_mfma_f32_32x32x16_bf16 v[24:39], v[92:95], v[136:139], v[24:39]
    v_mfma_f32_32x32x16_bf16 v[40:55], v[88:91], v[140:143], v[40:55]
    v_mfma_f32_32x32x16_bf16 v[56:71], v[92:95], v[140:143], v[56:71]
G_V3:
    s_waitcnt lgkmcnt(0)
    v_max3_u32 v155, v144, v145, v146
    v_max3_u32 v155, v155, v147, v148
    v_max3_u32 v155, v155, v149, v150
    v_max_u32 v155, v155, v151
    v_cmp_eq_u32 vcc, -1, v155
    s_nop 1
    s_and_b64 vcc, vcc, s[22:23]
    s_cbranch_scc0 G_OK3
    s_call_b64 s[20:21], G_RELOAD
    s_waitcnt vmcnt(0)
    ds_read_b128 v[144:147], v154 offset:6144
    ds_read_b128 v[148:151], v154 offset:7168
    s_branch G_V3
G_OK3:
    s_waitcnt vmcnt(6)
    ds_read_b128 v[136:139], v154 offset:8192
    ds_read_b128 v[140:143], v154 offset:9216
    v_mfma_f32_32x32x16_bf16 v[8:23], v[96:99], v[144:147], v[8:23]
    v_mfma_f32_32x32x16_bf16 v[24:39], v[100:103], v[144:147], v[24:39]
    v_mfma_f32_32x32x16_bf16 v[40:55], v[96:99], v[148:151], v[40:55]
    v_mfma_f32_32x32x16_bf16 v[56:71], v[100:103], v[148:151], v[56:71]
G_V4:
    s_waitcnt lgkmcnt(0)
    v_max3_u32 v155, v136, v137, v138
    v_max3_u32 v155, v155, v139, v140
    v_max3_u32 v155, v155, v141, v142
    v_max_u32 v155, v155, v143
    v_cmp_eq_u32 vcc, -1, v155
    s_nop 1
    s_and_b64 vcc, vcc, s[22:23]
    s_cbranch_scc0 G_OK4
    s_call_b64 s[20:21], G_RELOAD
    s_waitcnt vmcnt(0)
    ds_read_b128 v[136:139], v154 offset:8192
    ds_read_b128 v[140:143], v154 offset:9216
    s_branch G_V4
G_OK4:
    s_waitcnt vmcnt(4)
    ds_read_b128 v[144:147], v154 offset:10240
    ds_read_b128 v[148:151], v154 offset:11264
    v_mfma_f32_32x32x16_bf16 v[8:23], v[104:107], v[136:139], v[8:23]
    v_mfma_f32_32x32x16_bf16 v[24:39], v[108:111], v[136:139], v[24:39]
    v_mfma_f32_32x32x16_bf16 v[40:55], v[104:107], v[140:143], v[40:55]
    v_mfma_f32_32x32x16_bf16 v[56:71], v[108:111], v[140:143], v[56:71]
G_V5:
    s_waitcnt lgkmcnt(0)
    v_max3_u32 v155, v144, v145, v146
    v_max3_u32 v155, v155, v147, v148
    v_max3_u32 v155, v155, v149, v150
    v_max_u32 v155, v155, v151
    v_cmp_eq_u32 vcc, -1, v155
    s_nop 1
    s_and_b64 vcc, vcc, s[22:23]
    s_cbranch_scc0 G_OK5
    s_call_b64 s[20:21], G_RELOAD
    s_waitcnt vmcnt(0)
    ds_read_b128 v[144:147], v154 offset:10240
    ds_read_b128 v[148:151], v154 offset:11264
    s_branch G_V5
G_OK5:
    s_waitcnt vmcnt(2)
    ds_read_b128 v[136:139], v154 offset:12288
    ds_read_b128 v[140:143], v154 offset:13312
    v_mfma_f32_32x32x16_bf16 v[8:23], v[112:115], v[144:147], v[8:23]
    v_mfma_f32_32x32x16_bf16 v[24:39], v[116:119], v[144:147], v[24:39]
    v_mfma_f32_32x32x16_bf16 v[40:55], v[112:115], v[148:151], v[40:55]
    v_mfma_f32_32x32x16_bf16 v[56:71], v[116:119], v[148:151], v[56:71]
G_V6:
    s_waitcnt lgkmcnt(0)
    v_max3_u32 v155, v136, v137, v138
    v_max3_u32 v155, v155, v139, v140
    v_max3_u32 v155, v155, v141, v142
    v_max_u32 v155, v155, v143
    v_cmp_eq_u32 vcc, -1, v155
    s_nop 1
    s_and_b64 vcc, vcc, s[22:23]
    s_cbranch_scc0 G_OK6
    s_call_b64 s[20:21], G_RELOAD
    s_waitcnt vmcnt(0)
    ds_read_b128 v[136:139], v154 offset:12288
    ds_read_b128 v[140:143], v154 offset:13312
    s_branch G_V6
G_OK6:
    s_waitcnt vmcnt(0)
    ds_read_b128 v[144:147], v154 offset:14336
    ds_read_b128 v[148:151], v154 offset:15360
    v_mfma_f32_32x32x16_bf16 v[8:23], v[120:123], v[136:139], v[8:23]
    v_mfma_f32_32x32x16_bf16 v[24:39], v[124:127], v[136:139], v[24:39]
    v_mfma_f32_32x32x16_bf16 v[40:55], v[120:123], v[140:143], v[40:55]
    v_mfma_f32_32x32x16_bf16 v[56:71], v[124:127], v[140:143], v[56:71]
G_V7:
    s_waitcnt lgkmcnt(0)
    v_max3_u32 v155, v144, v145, v146
    v_max3_u32 v155, v155, v147, v148
    v_max3_u32 v155, v155, v149, v150
    v_max_u32 v155, v155, v151
    v_cmp_eq_u32 vcc, -1, v155
    s_nop 1
    s_and_b64 vcc, vcc, s[22:23]
    s_cbranch_scc0 G_OK7
    s_call_b64 s[20:21], G_RELOAD
    s_waitcnt vmcnt(0)
    ds_read_b128 v[144:147], v154 offset:14336
    ds_read_b128 v[148:151], v154 offset:15360
    s_branch G_V7
G_OK7:
    v_mfma_f32_32x32x16_bf16 v[8:23], v[128:131], v[144:147], v[8:23]
    v_mfma_f32_32x32x16_bf16 v[24:39], v[132:135], v[144:147], v[24:39]
    v_mfma_f32_32x32x16_bf16 v[40:55], v[128:131], v[148:151], v[40:55]
    v_mfma_f32_32x32x16_bf16 v[56:71], v[132:135], v[148:151], v[56:71]
    s_nop 7
    s_nop 7
    s_xor_b32 s74, s71, 1
    s_mul_i32 s74, s74, 12288
    s_add_u32 s74, s74, 65536
    v_add_u32 v3, s74, v2
    ds_write_b128 v3, v[24:27] offset:0
    ds_write_b128 v3, v[28:31] offset:1024
    ds_write_b128 v3, v[32:35] offset:2048
    ds_write_b128 v3, v[36:39] offset:3072
    s_xor_b32 s74, s71, 2
    s_mul_i32 s74, s74, 12288
    s_add_u32 s74, s74, 65536
    v_add_u32 v3, s74, v2
    ds_write_b128 v3, v[40:43] offset:4096
    ds_write_b128 v3, v[44:47] offset:5120
    ds_write_b128 v3, v[48:51] offset:6144
    ds_write_b128 v3, v[52:55] offset:7168
    s_xor_b32 s74, s71, 3
    s_mul_i32 s74, s74, 12288
    s_add_u32 s74, s74, 65536
    v_add_u32 v3, s74, v2
    ds_write_b128 v3, v[56:59] offset:8192
    ds_write_b128 v3, v[60:63] offset:9216
    ds_write_b128 v3, v[64:67] offset:10240
    ds_write_b128 v3, v[68:71] offset:11264
    s_mul_i32 s74, s71, 12288
    s_add_u32 s74, s74, 65536
    v_add_u32 v3, s74, v2
    s_waitcnt lgkmcnt(0)
    s_barrier
    ds_read_b128 v[72:75], v3 offset:0
    ds_read_b128 v[76:79], v3 offset:1024
    ds_read_b128 v[80:83], v3 offset:2048
    ds_read_b128 v[84:87], v3 offset:3072
    ds_read_b128 v[88:91], v3 offset:4096
    ds_read_b128 v[92:95], v3 offset:5120
    ds_read_b128 v[96:99], v3 offset:6144
    ds_read_b128 v[100:103], v3 offset:7168
    ds_read_b128 v[104:107], v3 offset:8192
    ds_read_b128 v[108:111], v3 offset:9216
    ds_read_b128 v[112:115], v3 offset:10240
    ds_read_b128 v[116:119], v3 offset:11264
    v_and_b32 v3, 31, v1
    v_lshlrev_b32 v3, 10, v3
    v_lshrrev_b32 v4, 5, v1
    v_lshl_add_u32 v3, v4, 5, v3
    s_lshl_b32 s74, s13, 15
    s_lshl_b32 s75, s14, 6
    s_add_u32 s74, s74, s75
    s_waitcnt lgkmcnt(8)
    v_add_f32 v8, v8, v72
    v_add_f32 v9, v9, v73
    v_add_f32 v10, v10, v74
    v_add_f32 v11, v11, v75
    v_add_f32 v12, v12, v76
    v_add_f32 v13, v13, v77
    v_add_f32 v14, v14, v78
    v_add_f32 v15, v15, v79
    v_add_f32 v16, v16, v80
    v_add_f32 v17, v17, v81
    v_add_f32 v18, v18, v82
    v_add_f32 v19, v19, v83
    v_add_f32 v20, v20, v84
    v_add_f32 v21, v21, v85
    v_add_f32 v22, v22, v86
    v_add_f32 v23, v23, v87
    s_waitcnt lgkmcnt(4)
    v_add_f32 v8, v8, v88
    v_add_f32 v9, v9, v89
    v_add_f32 v10, v10, v90
    v_add_f32 v11, v11, v91
    v_add_f32 v12, v12, v92
    v_add_f32 v13, v13, v93
    v_add_f32 v14, v14, v94
    v_add_f32 v15, v15, v95
    v_add_f32 v16, v16, v96
    v_add_f32 v17, v17, v97
    v_add_f32 v18, v18, v98
    v_add_f32 v19, v19, v99
    v_add_f32 v20, v20, v100
    v_add_f32 v21, v21, v101
    v_add_f32 v22, v22, v102
    v_add_f32 v23, v23, v103
    s_waitcnt lgkmcnt(0)
    v_add_f32 v8, v8, v104
    v_add_f32 v9, v9, v105
    v_add_f32 v10, v10, v106
    v_add_f32 v11, v11, v107
    v_add_f32 v12, v12, v108
    v_add_f32 v13, v13, v109
    v_add_f32 v14, v14, v110
    v_add_f32 v15, v15, v111
    v_add_f32 v16, v16, v112
    v_add_f32 v17, v17, v113
    v_add_f32 v18, v18, v114
    v_add_f32 v19, v19, v115
    v_add_f32 v20, v20, v116
    v_add_f32 v21, v21, v117
    v_add_f32 v22, v22, v118
    v_add_f32 v23, v23, v119
    v_cvt_pk_bf16_f32 v8, v8, v9
    v_cvt_pk_bf16_f32 v9, v10, v11
    v_cvt_pk_bf16_f32 v10, v12, v13
    v_cvt_pk_bf16_f32 v11, v14, v15
    v_cvt_pk_bf16_f32 v12, v16, v17
    v_cvt_pk_bf16_f32 v13, v18, v19
    v_cvt_pk_bf16_f32 v14, v20, v21
    v_cvt_pk_bf16_f32 v15, v22, v23
    buffer_store_dwordx4 v[8:11], v3, s[60:63], s74 offen
    buffer_store_dwordx4 v[12:15], v3, s[60:63], s74 offen offset:16
    s_endpgm
A_START:
    s_lshl_b32 s74, s71, 12
    v_and_b32 v3, 31, v1
    v_lshrrev_b32 v4, 5, v1
    v_bfe_u32 v11, v1, 1, 3
    v_xor_b32 v11, v11, v4
    v_lshlrev_b32 v3, 7, v3
    v_add_u32 v3, s74, v3
    v_xor_b32 v5, 0, v11
    v_lshl_add_u32 v5, v5, 4, v3
    v_xor_b32 v6, 2, v11
    v_lshl_add_u32 v6, v6, 4, v3
    v_xor_b32 v7, 4, v11
    v_lshl_add_u32 v7, v7, 4, v3
    v_xor_b32 v8, 6, v11
    v_lshl_add_u32 v8, v8, 4, v3
    v_bfe_u32 v3, v1, 2, 2
    v_lshl_add_u32 v3, v4, 3, v3
    v_lshlrev_b32 v9, 6, v3
    v_bfe_u32 v3, v1, 4, 1
    v_lshl_add_u32 v9, v3, 5, v9
    v_and_b32 v3, 3, v1
    v_lshl_add_u32 v9, v3, 3, v9
    s_lshr_b32 s74, s68, 2
    s_lshl_b32 s74, s74, 13
    s_add_u32 s74, s74, 16384
    v_add_u32 v9, s74, v9
    v_lshlrev_b32 v10, 4, v4
    v_add_u32 v10, 147456, v10
    v_lshlrev_b32 v11, 3, v4
    s_lshr_b32 s74, s68, 2
    s_lshl_b32 s74, s74, 7
    s_add_u32 s74, s74, 148480
    v_add_u32 v11, s74, v11
    v_mov_b32 v64, 0
    v_mov_b32 v65, 0
    v_mov_b32 v66, 0
    v_mov_b32 v67, 0
    v_mov_b32 v68, 0
    v_mov_b32 v69, 0
    v_mov_b32 v70, 0
    v_mov_b32 v71, 0
    v_mov_b32 v72, 0
    v_mov_b32 v73, 0
    v_mov_b32 v74, 0
    v_mov_b32 v75, 0
    v_mov_b32 v76, 0
    v_mov_b32 v77, 0
    v_mov_b32 v78, 0
    v_mov_b32 v79, 0
    v_mov_b32 v80, 0
    v_mov_b32 v81, 0
    v_mov_b32 v82, 0
    v_mov_b32 v83, 0
    v_mov_b32 v84, 0
    v_mov_b32 v85, 0
    v_mov_b32 v86, 0
    v_mov_b32 v87, 0
    v_mov_b32 v88, 0
    v_mov_b32 v89, 0
    v_mov_b32 v90, 0
    v_mov_b32 v91, 0
    v_mov_b32 v92, 0
    v_mov_b32 v93, 0
    v_mov_b32 v94, 0
    v_mov_b32 v95, 0
    v_and_b32 v13, 27, v1
    v_cmp_eq_u32 vcc, 16, v13
    v_mov_b32 v14, 0x3f803f80
    s_nop 0
    v_cndmask_b32 v13, 0, v14, vcc
    v_mov_b32 v112, v13
    v_mov_b32 v113, v13
    v_mov_b32 v114, v13
    v_mov_b32 v115, v13
    v_mov_b32 v116, v13
    v_mov_b32 v117, v13
    v_mov_b32 v118, v13
    v_mov_b32 v119, v13
    v_mov_b32 v120, v13
    v_mov_b32 v121, v13
    v_mov_b32 v122, v13
    v_mov_b32 v123, v13
    v_mov_b32 v124, v13
    v_mov_b32 v125, v13
    v_mov_b32 v126, v13
    v_mov_b32 v127, v13
    v_mov_b32 v152, 0
    v_mov_b32 v153, 0
    v_mov_b32 v154, 0
    v_mov_b32 v155, 0
    v_mov_b32 v156, 0
    v_mov_b32 v157, 0
    v_mov_b32 v158, 0
    v_mov_b32 v159, 0
    v_mov_b32 v160, 0
    v_mov_b32 v161, 0
    v_mov_b32 v162, 0
    v_mov_b32 v163, 0
    v_mov_b32 v164, 0
    v_mov_b32 v165, 0
    v_mov_b32 v166, 0
    v_mov_b32 v167, 0
    v_mov_b32 v144, 0x3fb8aa3b
    v_mov_b32 v145, 0x3fb8aa3b
    v_mov_b32 v146, 0x40000000
    v_mov_b32 v147, 0x40000000
    v_mov_b32 v148, 0xc0000000
    v_mov_b32 v149, 0xc0000000
    v_mov_b32 v150, 0x3f800000
    v_mov_b32 v151, 0x3f800000
    s_mov_b32 s26, 0
    s_waitcnt lgkmcnt(0)
    s_mov_b32 s40, s24
    s_and_b32 s41, s25, 0xffff
    s_mov_b32 s42, 0x10000000
    s_mov_b32 s43, 0x00020000
    s_mov_b32 s44, s14
    s_and_b32 s45, s15, 0xffff
    s_mov_b32 s46, 0xe00
    s_mov_b32 s47, 0x00020000
    s_mov_b32 s48, s16
    s_and_b32 s49, s17, 0xffff
    s_mov_b32 s50, 0x1c0000
    s_mov_b32 s51, 0x00020000
    s_mov_b32 s52, s8
    s_and_b32 s53, s9, 0xffff
    s_mov_b32 s54, 0x80000
    s_mov_b32 s55, 0x00020000
    s_mov_b32 s60, s20
    s_and_b32 s61, s21, 0xffff
    s_mov_b32 s62, 0x200000
    s_mov_b32 s63, 0x00020000
    s_mov_b32 s64, s22
    s_and_b32 s65, s23, 0xffff
    s_mov_b32 s66, 0x100
    s_mov_b32 s67, 0x00020000
    s_barrier
    s_mov_b32 s77, 65536
    s_movk_i32 s27, 256
    s_cmp_ge_u32 s68, 4
    s_cbranch_scc1 A_L2P
    ds_read_b128 v[16:19], v5 offset:0
    ds_read_b64_tr_b16 v[20:21], v9 offset:0
    ds_read_b64_tr_b16 v[22:23], v9 offset:256
    ds_read_b64_tr_b16 v[24:25], v9 offset:4096
    ds_read_b64_tr_b16 v[26:27], v9 offset:4352
    ds_read_b128 v[28:31], v6 offset:0
    ds_read_b64_tr_b16 v[32:33], v9 offset:1024
    ds_read_b64_tr_b16 v[34:35], v9 offset:1280
    ds_read_b64_tr_b16 v[36:37], v9 offset:5120
    ds_read_b64_tr_b16 v[38:39], v9 offset:5376
    ds_read_b128 v[40:43], v7 offset:0
    ds_read_b64_tr_b16 v[44:45], v9 offset:2048
    ds_read_b64_tr_b16 v[46:47], v9 offset:2304
    ds_read_b64_tr_b16 v[48:49], v9 offset:6144
    ds_read_b64_tr_b16 v[50:51], v9 offset:6400
.p2align 3
A_L1:
    s_waitcnt lgkmcnt(10)
    s_add_u32 s26, s26, 2
    ds_read_b128 v[52:55], v8 offset:0
    ds_read_b64_tr_b16 v[56:57], v9 offset:3072
    ds_read_b64_tr_b16 v[58:59], v9 offset:3328
    ds_read_b64_tr_b16 v[60:61], v9 offset:7168
    ds_read_b64_tr_b16 v[62:63], v9 offset:7424
    v_mfma_f32_32x32x16_bf16 v[64:79], v[20:23], v[16:19], v[64:79]
    v_mfma_f32_32x32x16_bf16 v[80:95], v[24:27], v[16:19], v[80:95]
    s_waitcnt lgkmcnt(10)
    s_barrier
    ds_read_b128 v[16:19], v5 offset:32768
    ds_read_b64_tr_b16 v[20:21], v9 offset:32768
    ds_read_b64_tr_b16 v[22:23], v9 offset:33024
    ds_read_b64_tr_b16 v[24:25], v9 offset:36864
    ds_read_b64_tr_b16 v[26:27], v9 offset:37120
    v_mfma_f32_32x32x16_bf16 v[64:79], v[32:35], v[28:31], v[64:79]
    v_mfma_f32_32x32x16_bf16 v[80:95], v[36:39], v[28:31], v[80:95]
    s_waitcnt lgkmcnt(10)
    s_nop 0
    ds_read_b128 v[28:31], v6 offset:32768
    ds_read_b64_tr_b16 v[32:33], v9 offset:33792
    ds_read_b64_tr_b16 v[34:35], v9 offset:34048
    ds_read_b64_tr_b16 v[36:37], v9 offset:37888
    ds_read_b64_tr_b16 v[38:39], v9 offset:38144
    v_mfma_f32_32x32x16_bf16 v[64:79], v[44:47], v[40:43], v[64:79]
    v_mfma_f32_32x32x16_bf16 v[80:95], v[48:51], v[40:43], v[80:95]
    s_waitcnt lgkmcnt(10)
    s_nop 0
    ds_read_b128 v[40:43], v7 offset:32768
    ds_read_b64_tr_b16 v[44:45], v9 offset:34816
    ds_read_b64_tr_b16 v[46:47], v9 offset:35072
    ds_read_b64_tr_b16 v[48:49], v9 offset:38912
    ds_read_b64_tr_b16 v[50:51], v9 offset:39168
    v_mfma_f32_32x32x16_bf16 v[64:79], v[56:59], v[52:55], v[64:79]
    v_mfma_f32_32x32x16_bf16 v[80:95], v[60:63], v[52:55], v[80:95]
    s_waitcnt lgkmcnt(10)
    s_nop 0
    ds_read_b128 v[52:55], v8 offset:32768
    ds_read_b64_tr_b16 v[56:57], v9 offset:35840
    ds_read_b64_tr_b16 v[58:59], v9 offset:36096
    ds_read_b64_tr_b16 v[60:61], v9 offset:39936
    ds_read_b64_tr_b16 v[62:63], v9 offset:40192
    v_mfma_f32_32x32x16_bf16 v[64:79], v[20:23], v[16:19], v[64:79]
    v_mfma_f32_32x32x16_bf16 v[80:95], v[24:27], v[16:19], v[80:95]
    s_waitcnt lgkmcnt(10)
    v_xor_b32 v5, s77, v5
    v_xor_b32 v6, s77, v6
    v_xor_b32 v7, s77, v7
    v_xor_b32 v8, s77, v8
    v_xor_b32 v9, s77, v9
    s_cmp_eq_u32 s26, 12
    s_cbranch_scc0 A_NOVM_7
    s_waitcnt vmcnt(0)
A_NOVM_7:
    s_barrier
    ds_read_b128 v[16:19], v5 offset:0
    ds_read_b64_tr_b16 v[20:21], v9 offset:0
    ds_read_b64_tr_b16 v[22:23], v9 offset:256
    ds_read_b64_tr_b16 v[24:25], v9 offset:4096
    ds_read_b64_tr_b16 v[26:27], v9 offset:4352
    v_mfma_f32_32x32x16_bf16 v[64:79], v[32:35], v[28:31], v[64:79]
    v_mfma_f32_32x32x16_bf16 v[80:95], v[36:39], v[28:31], v[80:95]
    s_waitcnt lgkmcnt(10)
    s_nop 0
    ds_read_b128 v[28:31], v6 offset:0
    ds_read_b64_tr_b16 v[32:33], v9 offset:1024
    ds_read_b64_tr_b16 v[34:35], v9 offset:1280
    ds_read_b64_tr_b16 v[36:37], v9 offset:5120
    ds_read_b64_tr_b16 v[38:39], v9 offset:5376
    v_mfma_f32_32x32x16_bf16 v[64:79], v[44:47], v[40:43], v[64:79]
    v_mfma_f32_32x32x16_bf16 v[80:95], v[48:51], v[40:43], v[80:95]
    s_waitcnt lgkmcnt(10)
    s_and_b32 s74, s26, 7
    ds_read_b128 v[40:43], v7 offset:0
    ds_read_b64_tr_b16 v[44:45], v9 offset:2048
    ds_read_b64_tr_b16 v[46:47], v9 offset:2304
    ds_read_b64_tr_b16 v[48:49], v9 offset:6144
    ds_read_b64_tr_b16 v[50:51], v9 offset:6400
    v_mfma_f32_32x32x16_bf16 v[64:79], v[56:59], v[52:55], v[64:79]
    v_mfma_f32_32x32x16_bf16 v[80:95], v[60:63], v[52:55], v[80:95]
    s_cbranch_scc1 A_L1
    s_cmp_eq_u32 s26, 16
    s_cbranch_scc1 A_MISH
    s_waitcnt lgkmcnt(7)
    ds_read_b64 v[96:97], v11 offset:0
    ds_read_b64 v[98:99], v11 offset:16
    ds_read_b64 v[100:101], v11 offset:32
    ds_read_b64 v[102:103], v11 offset:48
    ds_read_b64 v[104:105], v11 offset:64
    ds_read_b64 v[106:107], v11 offset:80
    ds_read_b64 v[108:109], v11 offset:96
    ds_read_b64 v[110:111], v11 offset:112
    v_and_b32 v3, 0x33, v1
    v_bfe_u32 v4, v1, 2, 1
    v_lshl_add_u32 v3, v4, 3, v3
    v_bfe_u32 v4, v1, 3, 1
    v_lshl_add_u32 v3, v4, 2, v3
    v_lshlrev_b32 v3, 4, v3
    s_lshl_b32 s4, s70, 17
    s_lshl_b32 s5, s72, 10
    s_add_u32 s4, s4, s5
    s_lshl_b32 s6, s4, 1
    s_add_u32 s4, s4, 0x0
    s_add_u32 s5, s4, 65536
    s_add_u32 s6, s6, 0x200000
    s_add_u32 s7, s6, 131072
    s_mov_b32 s8, 0x3eb8aa3b
    s_mov_b32 s9, 0x3eb8aa3b
    v_pk_mul_f32 v[64:65], v[64:65], s[8:9]
    v_pk_mul_f32 v[66:67], v[66:67], s[8:9]
    v_pk_mul_f32 v[68:69], v[68:69], s[8:9]
    v_pk_mul_f32 v[70:71], v[70:71], s[8:9]
    v_pk_mul_f32 v[72:73], v[72:73], s[8:9]
    v_pk_mul_f32 v[74:75], v[74:75], s[8:9]
    v_pk_mul_f32 v[76:77], v[76:77], s[8:9]
    v_pk_mul_f32 v[78:79], v[78:79], s[8:9]
    v_cvt_pk_bf16_f32 v128, v64, v65
    v_cvt_pk_bf16_f32 v129, v66, v67
    v_cvt_pk_bf16_f32 v130, v68, v69
    v_cvt_pk_bf16_f32 v131, v70, v71
    v_cvt_pk_bf16_f32 v132, v72, v73
    v_cvt_pk_bf16_f32 v133, v74, v75
    v_cvt_pk_bf16_f32 v134, v76, v77
    v_cvt_pk_bf16_f32 v135, v78, v79
    v_cvt_pk_bf16_f32 v136, v80, v81
    v_cvt_pk_bf16_f32 v137, v82, v83
    v_cvt_pk_bf16_f32 v138, v84, v85
    v_cvt_pk_bf16_f32 v139, v86, v87
    v_cvt_pk_bf16_f32 v140, v88, v89
    v_cvt_pk_bf16_f32 v141, v90, v91
    v_cvt_pk_bf16_f32 v142, v92, v93
    v_cvt_pk_bf16_f32 v143, v94, v95
    buffer_store_dwordx4 v[136:139], v3, s[40:43], s6 offen sc1
    buffer_store_dwordx4 v[140:143], v3, s[40:43], s7 offen sc1
    buffer_store_dwordx4 v[128:131], v2, s[40:43], s4 offen sc1
    buffer_store_dwordx4 v[132:135], v2, s[40:43], s5 offen sc1
A_BIAS:
    s_waitcnt lgkmcnt(0)
    v_lshlrev_b32 v64, 16, v96
    v_and_b32 v65, 0xffff0000, v96
    v_lshlrev_b32 v66, 16, v97
    v_and_b32 v67, 0xffff0000, v97
    v_lshlrev_b32 v68, 16, v98
    v_and_b32 v69, 0xffff0000, v98
    v_lshlrev_b32 v70, 16, v99
    v_and_b32 v71, 0xffff0000, v99
    v_lshlrev_b32 v72, 16, v100
    v_and_b32 v73, 0xffff0000, v100
    v_lshlrev_b32 v74, 16, v101
    v_and_b32 v75, 0xffff0000, v101
    v_lshlrev_b32 v76, 16, v102
    v_and_b32 v77, 0xffff0000, v102
    v_lshlrev_b32 v78, 16, v103
    v_and_b32 v79, 0xffff0000, v103
    v_lshlrev_b32 v80, 16, v104
    v_and_b32 v81, 0xffff0000, v104
    v_lshlrev_b32 v82, 16, v105
    v_and_b32 v83, 0xffff0000, v105
    v_lshlrev_b32 v84, 16, v106
    v_and_b32 v85, 0xffff0000, v106
    v_lshlrev_b32 v86, 16, v107
    v_and_b32 v87, 0xffff0000, v107
    v_lshlrev_b32 v88, 16, v108
    v_and_b32 v89, 0xffff0000, v108
    v_lshlrev_b32 v90, 16, v109
    v_and_b32 v91, 0xffff0000, v109
    v_lshlrev_b32 v92, 16, v110
    v_and_b32 v93, 0xffff0000, v110
    v_lshlrev_b32 v94, 16, v111
    v_and_b32 v95, 0xffff0000, v111
    s_branch A_L1
A_L2P:
    ds_read_b128 v[16:19], v5 offset:0
    ds_read_b64_tr_b16 v[20:21], v9 offset:0
    ds_read_b64_tr_b16 v[22:23], v9 offset:256
    ds_read_b128 v[24:27], v10 offset:0
    ds_read_b128 v[28:31], v6 offset:0
    ds_read_b64_tr_b16 v[32:33], v9 offset:1024
    ds_read_b64_tr_b16 v[34:35], v9 offset:1280
    ds_read_b128 v[36:39], v10 offset:32
    ds_read_b128 v[40:43], v7 offset:0
    ds_read_b64_tr_b16 v[44:45], v9 offset:2048
    ds_read_b64_tr_b16 v[46:47], v9 offset:2304
    ds_read_b128 v[48:51], v10 offset:64
.p2align 3
A_L2:
    s_waitcnt lgkmcnt(8)
    s_add_u32 s26, s26, 2
    ds_read_b128 v[52:55], v8 offset:0
    ds_read_b64_tr_b16 v[56:57], v9 offset:3072
    ds_read_b64_tr_b16 v[58:59], v9 offset:3328
    ds_read_b128 v[60:63], v10 offset:96
    v_mfma_f32_32x32x16_bf16 v[64:79], v[16:19], v[20:23], v[64:79]
    v_dot2_f32_bf16 v80, v16, v24, v80
    v_dot2_f32_bf16 v80, v17, v25, v80
    v_dot2_f32_bf16 v80, v18, v26, v80
    v_dot2_f32_bf16 v80, v19, v27, v80
    s_waitcnt lgkmcnt(8)
    s_barrier
    ds_read_b128 v[16:19], v5 offset:32768
    ds_read_b64_tr_b16 v[20:21], v9 offset:32768
    ds_read_b64_tr_b16 v[22:23], v9 offset:33024
    ds_read_b128 v[24:27], v10 offset:128
    v_mfma_f32_32x32x16_bf16 v[64:79], v[28:31], v[32:35], v[64:79]
    v_dot2_f32_bf16 v80, v28, v36, v80
    v_dot2_f32_bf16 v80, v29, v37, v80
    v_dot2_f32_bf16 v80, v30, v38, v80
    v_dot2_f32_bf16 v80, v31, v39, v80
    s_waitcnt lgkmcnt(8)
    s_nop 0
    ds_read_b128 v[28:31], v6 offset:32768
    ds_read_b64_tr_b16 v[32:33], v9 offset:33792
    ds_read_b64_tr_b16 v[34:35], v9 offset:34048
    ds_read_b128 v[36:39], v10 offset:160
    v_mfma_f32_32x32x16_bf16 v[64:79], v[40:43], v[44:47], v[64:79]
    v_dot2_f32_bf16 v80, v40, v48, v80
    v_dot2_f32_bf16 v80, v41, v49, v80
    v_dot2_f32_bf16 v80, v42, v50, v80
    v_dot2_f32_bf16 v80, v43, v51, v80
    s_waitcnt lgkmcnt(8)
    s_nop 0
    ds_read_b128 v[40:43], v7 offset:32768
    ds_read_b64_tr_b16 v[44:45], v9 offset:34816
    ds_read_b64_tr_b16 v[46:47], v9 offset:35072
    ds_read_b128 v[48:51], v10 offset:192
    v_mfma_f32_32x32x16_bf16 v[64:79], v[52:55], v[56:59], v[64:79]
    v_dot2_f32_bf16 v80, v52, v60, v80
    v_dot2_f32_bf16 v80, v53, v61, v80
    v_dot2_f32_bf16 v80, v54, v62, v80
    v_dot2_f32_bf16 v80, v55, v63, v80
    s_waitcnt lgkmcnt(8)
    s_nop 0
    ds_read_b128 v[52:55], v8 offset:32768
    ds_read_b64_tr_b16 v[56:57], v9 offset:35840
    ds_read_b64_tr_b16 v[58:59], v9 offset:36096
    ds_read_b128 v[60:63], v10 offset:224
    v_mfma_f32_32x32x16_bf16 v[64:79], v[16:19], v[20:23], v[64:79]
    v_dot2_f32_bf16 v80, v16, v24, v80
    v_dot2_f32_bf16 v80, v17, v25, v80
    v_dot2_f32_bf16 v80, v18, v26, v80
    v_dot2_f32_bf16 v80, v19, v27, v80
    s_waitcnt lgkmcnt(8)
    v_xor_b32 v5, s77, v5
    v_xor_b32 v6, s77, v6
    v_xor_b32 v7, s77, v7
    v_xor_b32 v8, s77, v8
    v_xor_b32 v9, s77, v9
    v_add_u32 v10, s27, v10
    s_barrier
    ds_read_b128 v[16:19], v5 offset:0
    ds_read_b64_tr_b16 v[20:21], v9 offset:0
    ds_read_b64_tr_b16 v[22:23], v9 offset:256
    ds_read_b128 v[24:27], v10 offset:0
    v_mfma_f32_32x32x16_bf16 v[64:79], v[28:31], v[32:35], v[64:79]
    v_dot2_f32_bf16 v80, v28, v36, v80
    v_dot2_f32_bf16 v80, v29, v37, v80
    v_dot2_f32_bf16 v80, v30, v38, v80
    v_dot2_f32_bf16 v80, v31, v39, v80
    s_waitcnt lgkmcnt(8)
    s_nop 0
    ds_read_b128 v[28:31], v6 offset:0
    ds_read_b64_tr_b16 v[32:33], v9 offset:1024
    ds_read_b64_tr_b16 v[34:35], v9 offset:1280
    ds_read_b128 v[36:39], v10 offset:32
    v_mfma_f32_32x32x16_bf16 v[64:79], v[40:43], v[44:47], v[64:79]
    v_dot2_f32_bf16 v80, v40, v48, v80
    v_dot2_f32_bf16 v80, v41, v49, v80
    v_dot2_f32_bf16 v80, v42, v50, v80
    v_dot2_f32_bf16 v80, v43, v51, v80
    s_waitcnt lgkmcnt(8)
    s_and_b32 s74, s26, 7
    ds_read_b128 v[40:43], v7 offset:0
    ds_read_b64_tr_b16 v[44:45], v9 offset:2048
    ds_read_b64_tr_b16 v[46:47], v9 offset:2304
    ds_read_b128 v[48:51], v10 offset:64
    v_mfma_f32_32x32x16_bf16 v[64:79], v[52:55], v[56:59], v[64:79]
    v_dot2_f32_bf16 v80, v52, v60, v80
    v_dot2_f32_bf16 v80, v53, v61, v80
    v_dot2_f32_bf16 v80, v54, v62, v80
    v_dot2_f32_bf16 v80, v55, v63, v80
    s_cbranch_scc1 A_L2
    s_waitcnt lgkmcnt(0)
    ds_read_b64_tr_b16 v[24:25], v9 offset:4096
    ds_read_b64_tr_b16 v[26:27], v9 offset:4352
    ds_read_b64_tr_b16 v[36:37], v9 offset:5120
    ds_read_b64_tr_b16 v[38:39], v9 offset:5376
    ds_read_b64_tr_b16 v[48:49], v9 offset:6144
    ds_read_b64_tr_b16 v[50:51], v9 offset:6400
    s_waitcnt lgkmcnt(7)
    ds_read_b64 v[96:97], v11 offset:0
    ds_read_b64 v[98:99], v11 offset:16
    ds_read_b64 v[100:101], v11 offset:32
    ds_read_b64 v[102:103], v11 offset:48
    ds_read_b64 v[104:105], v11 offset:64
    ds_read_b64 v[106:107], v11 offset:80
    ds_read_b64 v[108:109], v11 offset:96
    ds_read_b64 v[110:111], v11 offset:112
    v_and_b32 v3, 0x2f, v1
    v_lshlrev_b32 v3, 4, v3
    v_bfe_u32 v4, v1, 4, 1
    v_lshl_add_u32 v3, v4, 17, v3
    s_lshl_b32 s4, s70, 18
    s_lshl_b32 s5, s72, 11
    s_add_u32 s4, s4, s5
    s_add_u32 s4, s4, 0x200000
    s_lshl_b32 s5, s72, 7
    s_add_u32 s5, s5, 0xf40000
    s_lshl_b32 s6, s70, 13
    s_add_u32 s5, s5, s6
    v_lshlrev_b32 v4, 2, v1
    v_mov_b32 v81, v80
    v_cvt_pk_bf16_f32 v128, v64, v65
    v_cvt_pk_bf16_f32 v129, v66, v67
    v_cvt_pk_bf16_f32 v130, v68, v69
    v_cvt_pk_bf16_f32 v131, v70, v71
    v_cvt_pk_bf16_f32 v132, v72, v73
    v_cvt_pk_bf16_f32 v133, v74, v75
    v_cvt_pk_bf16_f32 v134, v76, v77
    v_cvt_pk_bf16_f32 v135, v78, v79
    v_permlane32_swap_b32 v80, v81
    s_nop 1
    v_add_f32 v80, v80, v81
    v_mul_f32 v136, 0xbfb8aa3b, v80
    v_exp_f32 v136, v136
    buffer_store_dwordx4 v[128:131], v3, s[40:43], s4 offen offset:1024 sc1
    v_add_f32 v136, 1.0, v136
    v_rcp_f32 v136, v136
    buffer_store_dwordx4 v[132:135], v3, s[40:43], s4 offen offset:1280 sc1
    s_mov_b32 exec_hi, 0
    buffer_store_dword v136, v4, s[40:43], s5 offen sc1
    s_mov_b64 exec, -1
    s_waitcnt lgkmcnt(0)
    s_branch A_BIAS
A_MISH:
    s_mul_i32 s13, s72, 112
    s_lshl_b32 s75, s73, 1
    s_add_u32 s13, s13, s75
    s_lshr_b32 s75, s68, 2
    s_lshl_b32 s75, s75, 2
    s_add_u32 s13, s13, s75
    s_lshl_b32 s13, s13, 10
    s_add_u32 s13, s13, 0x600000
    s_cmp_ge_u32 s70, 14
    s_cselect_b32 s13, 0x40000000, s13
    s_waitcnt lgkmcnt(0)
    s_nop 3
    v_pk_mul_f32 v[16:17], v[64:65], v[144:145]
    v_pk_mul_f32 v[18:19], v[66:67], v[144:145]
    v_exp_f32 v16, v16
    v_exp_f32 v17, v17
    v_exp_f32 v18, v18
    v_exp_f32 v19, v19
    v_pk_add_f32 v[20:21], v[16:17], v[146:147]
    v_pk_add_f32 v[22:23], v[18:19], v[146:147]
    v_pk_fma_f32 v[20:21], v[16:17], v[20:21], v[146:147]
    v_pk_fma_f32 v[22:23], v[18:19], v[22:23], v[146:147]
    v_rcp_f32 v20, v20
    v_rcp_f32 v21, v21
    v_rcp_f32 v22, v22
    v_rcp_f32 v23, v23
    v_pk_fma_f32 v[20:21], v[20:21], v[148:149], v[150:151]
    v_pk_fma_f32 v[22:23], v[22:23], v[148:149], v[150:151]
    v_pk_mul_f32 v[20:21], v[20:21], v[64:65]
    v_pk_mul_f32 v[22:23], v[22:23], v[66:67]
    v_cvt_pk_bf16_f32 v128, v20, v21
    v_cvt_pk_bf16_f32 v129, v22, v23
    v_pk_mul_f32 v[16:17], v[68:69], v[144:145]
    v_pk_mul_f32 v[18:19], v[70:71], v[144:145]
    v_exp_f32 v16, v16
    v_exp_f32 v17, v17
    v_exp_f32 v18, v18
    v_exp_f32 v19, v19
    v_pk_add_f32 v[20:21], v[16:17], v[146:147]
    v_pk_add_f32 v[22:23], v[18:19], v[146:147]
    v_pk_fma_f32 v[20:21], v[16:17], v[20:21], v[146:147]
    v_pk_fma_f32 v[22:23], v[18:19], v[22:23], v[146:147]
    v_rcp_f32 v20, v20
    v_rcp_f32 v21, v21
    v_rcp_f32 v22, v22
    v_rcp_f32 v23, v23
    v_pk_fma_f32 v[20:21], v[20:21], v[148:149], v[150:151]
    v_pk_fma_f32 v[22:23], v[22:23], v[148:149], v[150:151]
    v_pk_mul_f32 v[20:21], v[20:21], v[68:69]
    v_pk_mul_f32 v[22:23], v[22:23], v[70:71]
    v_cvt_pk_bf16_f32 v130, v20, v21
    v_cvt_pk_bf16_f32 v131, v22, v23
    v_pk_mul_f32 v[16:17], v[72:73], v[144:145]
    v_pk_mul_f32 v[18:19], v[74:75], v[144:145]
    v_exp_f32 v16, v16
    v_exp_f32 v17, v17
    v_exp_f32 v18, v18
    v_exp_f32 v19, v19
    v_pk_add_f32 v[20:21], v[16:17], v[146:147]
    v_pk_add_f32 v[22:23], v[18:19], v[146:147]
    v_pk_fma_f32 v[20:21], v[16:17], v[20:21], v[146:147]
    v_pk_fma_f32 v[22:23], v[18:19], v[22:23], v[146:147]
    v_rcp_f32 v20, v20
    v_rcp_f32 v21, v21
    v_rcp_f32 v22, v22
    v_rcp_f32 v23, v23
    v_pk_fma_f32 v[20:21], v[20:21], v[148:149], v[150:151]
    v_pk_fma_f32 v[22:23], v[22:23], v[148:149], v[150:151]
    v_pk_mul_f32 v[20:21], v[20:21], v[72:73]
    v_pk_mul_f32 v[22:23], v[22:23], v[74:75]
    v_cvt_pk_bf16_f32 v132, v20, v21
    v_cvt_pk_bf16_f32 v133, v22, v23
    v_pk_mul_f32 v[16:17], v[76:77], v[144:145]
    v_pk_mul_f32 v[18:19], v[78:79], v[144:145]
    v_exp_f32 v16, v16
    v_exp_f32 v17, v17
    v_exp_f32 v18, v18
    v_exp_f32 v19, v19
    v_pk_add_f32 v[20:21], v[16:17], v[146:147]
    v_pk_add_f32 v[22:23], v[18:19], v[146:147]
    v_pk_fma_f32 v[20:21], v[16:17], v[20:21], v[146:147]
    v_pk_fma_f32 v[22:23], v[18:19], v[22:23], v[146:147]
    v_rcp_f32 v20, v20
    v_rcp_f32 v21, v21
    v_rcp_f32 v22, v22
    v_rcp_f32 v23, v23
    v_pk_fma_f32 v[20:21], v[20:21], v[148:149], v[150:151]
    v_pk_fma_f32 v[22:23], v[22:23], v[148:149], v[150:151]
    v_pk_mul_f32 v[20:21], v[20:21], v[76:77]
    v_pk_mul_f32 v[22:23], v[22:23], v[78:79]
    v_cvt_pk_bf16_f32 v134, v20, v21
    v_cvt_pk_bf16_f32 v135, v22, v23
    buffer_store_dwordx4 v[128:131], v2, s[40:43], s13 offen sc1
    buffer_store_dwordx4 v[132:135], v2, s[40:43], s13 offen offset:1024 sc1
    v_pk_mul_f32 v[16:17], v[80:81], v[144:145]
    v_pk_mul_f32 v[18:19], v[82:83], v[144:145]
    v_exp_f32 v16, v16
    v_exp_f32 v17, v17
    v_exp_f32 v18, v18
    v_exp_f32 v19, v19
    v_pk_add_f32 v[20:21], v[16:17], v[146:147]
    v_pk_add_f32 v[22:23], v[18:19], v[146:147]
    v_pk_fma_f32 v[20:21], v[16:17], v[20:21], v[146:147]
    v_pk_fma_f32 v[22:23], v[18:19], v[22:23], v[146:147]
    v_rcp_f32 v20, v20
    v_rcp_f32 v21, v21
    v_rcp_f32 v22, v22
    v_rcp_f32 v23, v23
    v_pk_fma_f32 v[20:21], v[20:21], v[148:149], v[150:151]
    v_pk_fma_f32 v[22:23], v[22:23], v[148:149], v[150:151]
    v_pk_mul_f32 v[20:21], v[20:21], v[80:81]
    v_pk_mul_f32 v[22:23], v[22:23], v[82:83]
    v_cvt_pk_bf16_f32 v136, v20, v21
    v_cvt_pk_bf16_f32 v137, v22, v23
    v_pk_mul_f32 v[16:17], v[84:85], v[144:145]
    v_pk_mul_f32 v[18:19], v[86:87], v[144:145]
    v_exp_f32 v16, v16
    v_exp_f32 v17, v17
    v_exp_f32 v18, v18
    v_exp_f32 v19, v19
    v_pk_add_f32 v[20:21], v[16:17], v[146:147]
    v_pk_add_f32 v[22:23], v[18:19], v[146:147]
    v_pk_fma_f32 v[20:21], v[16:17], v[20:21], v[146:147]
    v_pk_fma_f32 v[22:23], v[18:19], v[22:23], v[146:147]
    v_rcp_f32 v20, v20
    v_rcp_f32 v21, v21
    v_rcp_f32 v22, v22
    v_rcp_f32 v23, v23
    v_pk_fma_f32 v[20:21], v[20:21], v[148:149], v[150:151]
    v_pk_fma_f32 v[22:23], v[22:23], v[148:149], v[150:151]
    v_pk_mul_f32 v[20:21], v[20:21], v[84:85]
    v_pk_mul_f32 v[22:23], v[22:23], v[86:87]
    v_cvt_pk_bf16_f32 v138, v20, v21
    v_cvt_pk_bf16_f32 v139, v22, v23
    v_pk_mul_f32 v[16:17], v[88:89], v[144:145]
    v_pk_mul_f32 v[18:19], v[90:91], v[144:145]
    v_exp_f32 v16, v16
    v_exp_f32 v17, v17
    v_exp_f32 v18, v18
    v_exp_f32 v19, v19
    v_pk_add_f32 v[20:21], v[16:17], v[146:147]
    v_pk_add_f32 v[22:23], v[18:19], v[146:147]
    v_pk_fma_f32 v[20:21], v[16:17], v[20:21], v[146:147]
    v_pk_fma_f32 v[22:23], v[18:19], v[22:23], v[146:147]
    v_rcp_f32 v20, v20
    v_rcp_f32 v21, v21
    v_rcp_f32 v22, v22
    v_rcp_f32 v23, v23
    v_pk_fma_f32 v[20:21], v[20:21], v[148:149], v[150:151]
    v_pk_fma_f32 v[22:23], v[22:23], v[148:149], v[150:151]
    v_pk_mul_f32 v[20:21], v[20:21], v[88:89]
    v_pk_mul_f32 v[22:23], v[22:23], v[90:91]
    v_cvt_pk_bf16_f32 v140, v20, v21
    v_cvt_pk_bf16_f32 v141, v22, v23
    v_pk_mul_f32 v[16:17], v[92:93], v[144:145]
    v_pk_mul_f32 v[18:19], v[94:95], v[144:145]
    v_exp_f32 v16, v16
    v_exp_f32 v17, v17
    v_exp_f32 v18, v18
    v_exp_f32 v19, v19
    v_pk_add_f32 v[20:21], v[16:17], v[146:147]
    v_pk_add_f32 v[22:23], v[18:19], v[146:147]
    v_pk_fma_f32 v[20:21], v[16:17], v[20:21], v[146:147]
    v_pk_fma_f32 v[22:23], v[18:19], v[22:23], v[146:147]
    v_rcp_f32 v20, v20
    v_rcp_f32 v21, v21
    v_rcp_f32 v22, v22
    v_rcp_f32 v23, v23
    v_pk_fma_f32 v[20:21], v[20:21], v[148:149], v[150:151]
    v_pk_fma_f32 v[22:23], v[22:23], v[148:149], v[150:151]
    v_pk_mul_f32 v[20:21], v[20:21], v[92:93]
    v_pk_mul_f32 v[22:23], v[22:23], v[94:95]
    v_cvt_pk_bf16_f32 v142, v20, v21
    v_cvt_pk_bf16_f32 v143, v22, v23
    buffer_store_dwordx4 v[136:139], v2, s[40:43], s13 offen offset:2048 sc1
    buffer_store_dwordx4 v[140:143], v2, s[40:43], s13 offen offset:3072 sc1
A_PH2:
    s_and_b32 s74, s2, 7
    s_lshl_b32 s4, s74, 2
    s_bfe_u32 s74, s2, 0x20003
    s_add_u32 s4, s4, s74
    s_lshr_b32 s5, s2, 5
    s_lshl_b32 s5, s5, 3
    s_add_u32 s5, s5, s68
    v_mov_b32 v6, 0xdddddddd
    s_mov_b32 s10, 0x0000ffff
    s_mov_b32 s11, 0x0000ffff
    v_mov_b32 v5, v2
    s_mov_b32 s7, 1
    s_mov_b32 s9, 0
    s_lshl_b32 s74, s68, 10
    s_add_u32 s74, s74, 131072
    v_add_u32 v4, s74, v2
    s_lshl_b32 s12, s5, 15
    s_lshl_b32 s75, s4, 10
    s_add_u32 s12, s12, s75
    s_add_u32 s12, s12, 0x1000000
    v_mov_b32 v104, -1
    v_mov_b32 v105, -1
    v_mov_b32 v106, -1
    v_mov_b32 v107, -1
    buffer_store_dwordx4 v[104:107], v2, s[40:43], s12 offen sc1
    s_setprio 2
    s_barrier
    ds_read_b128 v[8:11], v4
    ds_read_b128 v[12:15], v5 offset:0
    s_waitcnt lgkmcnt(0)
    v_mfma_f32_32x32x16_bf16 v[36:51], v[12:15], v[8:11], 0
    s_nop 7
    s_nop 7
    v_max3_f32 v3, v36, v37, v38
    v_max3_f32 v3, v3, v39, v40
    v_max3_f32 v3, v3, v41, v42
    v_max3_f32 v3, v3, v43, v44
    v_max3_f32 v3, v3, v45, v46
    v_max3_f32 v3, v3, v47, v48
    v_max3_f32 v3, v3, v49, v50
    v_max_f32 v3, v3, v51
A_SETMAX:
    v_mov_b32 v4, v3
    s_nop 1
    v_permlane32_swap_b32 v3, v4
    s_nop 1
    v_max_f32 v3, v3, v4
    v_sub_f32 v68, 0, v3
    v_sub_f32 v69, 0, v3
    v_sub_f32 v70, 0, v3
    v_sub_f32 v71, 0, v3
    v_sub_f32 v72, 0, v3
    v_sub_f32 v73, 0, v3
    v_sub_f32 v74, 0, v3
    v_sub_f32 v75, 0, v3
    v_sub_f32 v76, 0, v3
    v_sub_f32 v77, 0, v3
    v_sub_f32 v78, 0, v3
    v_sub_f32 v79, 0, v3
    v_sub_f32 v80, 0, v3
    v_sub_f32 v81, 0, v3
    v_sub_f32 v82, 0, v3
    v_sub_f32 v83, 0, v3
    ds_read_b128 v[12:15], v5 offset:0
    ds_read_b128 v[16:19], v5 offset:2048
    s_mov_b64 exec, s[10:11]
    ds_read_b128 v[112:115], v5 offset:1024
    ds_read_b128 v[116:119], v5 offset:1280
    s_mov_b64 exec, -1
    s_waitcnt lgkmcnt(0)
    v_mfma_f32_32x32x16_bf16 v[36:51], v[12:15], v[8:11], v[68:83]
    s_mov_b32 s6, 0
    v_mov_b32 v60, 0
    v_mov_b32 v61, 0
    v_mov_b32 v62, 0
    v_mov_b32 v63, 0
    v_mov_b32 v64, 0
    v_mov_b32 v65, 0
    v_mov_b32 v66, 0
    v_mov_b32 v67, 0
    s_nop 7
.p2align 6
A_LOOP:
    v_exp_f32 v36, v36
    v_exp_f32 v37, v37
    v_smfmac_f32_32x32x32_bf16 v[152:167], v[124:127], v[60:67], v6
    v_exp_f32 v38, v38
    v_exp_f32 v39, v39
    v_exp_f32 v40, v40
    v_exp_f32 v41, v41
    v_exp_f32 v42, v42
    s_waitcnt lgkmcnt(0)
    v_mfma_f32_32x32x16_bf16 v[52:67], v[16:19], v[8:11], v[68:83]
    ds_read_b128 v[12:15], v5 offset:4096
    v_exp_f32 v43, v43
    s_mov_b64 exec, s[10:11]
    ds_read_b128 v[120:123], v5 offset:3072
    ds_read_b128 v[124:127], v5 offset:3328
    s_mov_b64 exec, -1
    v_exp_f32 v44, v44
    v_exp_f32 v45, v45
    v_exp_f32 v46, v46
    v_exp_f32 v47, v47
    v_exp_f32 v48, v48
    v_smfmac_f32_32x32x32_bf16 v[152:167], v[112:115], v[36:43], v6
    v_exp_f32_e64 v49, v49
    v_exp_f32 v50, v50
    v_exp_f32 v51, v51
    v_exp_f32 v52, v52
    v_exp_f32 v53, v53
    v_smfmac_f32_32x32x32_bf16 v[152:167], v[116:119], v[44:51], v6
    v_exp_f32 v54, v54
    v_exp_f32 v55, v55
    v_exp_f32 v56, v56
    v_exp_f32 v57, v57
    v_exp_f32 v58, v58
    s_waitcnt lgkmcnt(0)
    v_mfma_f32_32x32x16_bf16 v[36:51], v[12:15], v[8:11], v[68:83]
    ds_read_b128 v[16:19], v5 offset:6144
    v_exp_f32 v59, v59
    s_mov_b64 exec, s[10:11]
    ds_read_b128 v[112:115], v5 offset:5120
    ds_read_b128 v[116:119], v5 offset:5376
    s_mov_b64 exec, -1
    v_exp_f32 v60, v60
    v_exp_f32 v61, v61
    v_exp_f32 v62, v62
    v_exp_f32 v63, v63
    v_exp_f32 v64, v64
    v_smfmac_f32_32x32x32_bf16 v[152:167], v[120:123], v[52:59], v6
    v_exp_f32_e64 v65, v65
    v_exp_f32 v66, v66
    v_exp_f32 v67, v67
    v_exp_f32 v36, v36
    v_exp_f32 v37, v37
    v_smfmac_f32_32x32x32_bf16 v[152:167], v[124:127], v[60:67], v6
    v_exp_f32 v38, v38
    v_exp_f32 v39, v39
    v_exp_f32 v40, v40
    v_exp_f32 v41, v41
    v_exp_f32 v42, v42
    s_waitcnt lgkmcnt(0)
    v_mfma_f32_32x32x16_bf16 v[52:67], v[16:19], v[8:11], v[68:83]
    ds_read_b128 v[12:15], v5 offset:8192
    v_exp_f32 v43, v43
    s_mov_b64 exec, s[10:11]
    ds_read_b128 v[120:123], v5 offset:7168
    ds_read_b128 v[124:127], v5 offset:7424
    s_mov_b64 exec, -1
    v_exp_f32 v44, v44
    v_exp_f32 v45, v45
    v_exp_f32 v46, v46
    v_exp_f32 v47, v47
    v_exp_f32 v48, v48
    v_smfmac_f32_32x32x32_bf16 v[152:167], v[112:115], v[36:43], v6
    v_exp_f32_e64 v49, v49
    v_exp_f32 v50, v50
    v_exp_f32 v51, v51
    v_exp_f32 v52, v52
    v_exp_f32 v53, v53
    v_smfmac_f32_32x32x32_bf16 v[152:167], v[116:119], v[44:51], v6
    v_exp_f32 v54, v54
    v_exp_f32 v55, v55
    v_exp_f32 v56, v56
    v_exp_f32 v57, v57
    v_exp_f32 v58, v58
    s_waitcnt lgkmcnt(0)
    v_mfma_f32_32x32x16_bf16 v[36:51], v[12:15], v[8:11], v[68:83]
    ds_read_b128 v[16:19], v5 offset:10240
    v_exp_f32 v59, v59
    s_mov_b64 exec, s[10:11]
    ds_read_b128 v[112:115], v5 offset:9216
    ds_read_b128 v[116:119], v5 offset:9472
    s_mov_b64 exec, -1
    v_exp_f32 v60, v60
    v_exp_f32 v61, v61
    v_exp_f32 v62, v62
    v_exp_f32 v63, v63
    v_exp_f32 v64, v64
    v_smfmac_f32_32x32x32_bf16 v[152:167], v[120:123], v[52:59], v6
    v_add_u32 v5, 8192, v5
    v_exp_f32 v65, v65
    v_exp_f32 v66, v66
    v_exp_f32 v67, v67
    s_add_u32 s6, s6, 1
    s_cmp_lt_u32 s6, s7
    s_cbranch_scc1 A_LOOP
    s_cmp_eq_u32 s6, 1
    s_cbranch_scc0 A_SEG2
    s_mov_b32 s7, 3
    s_waitcnt vmcnt(0)
    s_barrier
    s_branch A_LOOP
A_SEG2:
    s_cmp_eq_u32 s6, 3
    s_cbranch_scc0 A_SEG3
    s_mov_b32 s7, 9
    s_waitcnt vmcnt(0)
    s_barrier
    s_branch A_LOOP
A_SEG3:
    s_cmp_eq_u32 s6, 9
    s_cbranch_scc0 A_SEG4
    s_mov_b32 s7, 13
    s_setprio 1
    v_and_b32 v3, 31, v1
    v_lshlrev_b32 v3, 2, v3
    s_lshl_b32 s74, s5, 7
    s_add_u32 s74, s74, 0xf40000
    s_lshr_b32 s75, s4, 1
    s_lshl_b32 s75, s75, 13
    s_add_u32 s74, s74, s75
    buffer_load_dword v7, v3, s[40:43], s74 offen sc1
    s_branch A_LOOP
A_SEG4:
    s_cmp_eq_u32 s6, 13
    s_cbranch_scc0 A_SEG5
    s_mov_b32 s7, 16
    s_setprio 0
    s_branch A_LOOP
A_SEG5:
    v_smfmac_f32_32x32x32_bf16 v[152:167], v[124:127], v[60:67], v6
    s_waitcnt lgkmcnt(0)
    s_nop 7
    s_nop 7
    s_cmp_lg_u32 s9, 0
    s_cbranch_scc1 A_FIN
    v_max3_f32 v3, |v152|, |v153|, |v154|
    v_max3_f32 v3, v3, |v155|, |v156|
    v_max3_f32 v3, v3, |v157|, |v158|
    v_max_f32 v3, v3, |v159|
    v_mov_b32 v4, 0x7f800000
    v_cmp_nlt_f32 vcc, v3, v4
    v_mov_b32 v4, 0x4e800000
    v_cmp_nlt_f32 s[76:77], v160, v4
    s_nop 1
    s_or_b64 vcc, vcc, s[76:77]
    s_cbranch_scc0 A_FIN
    s_mov_b32 s9, 1
    s_mov_b32 s7, 16
    v_mov_b32 v5, v2
    v_mov_b32 v3, 0xff800000
    s_mov_b32 s6, 0
A_MAXLOOP:
    ds_read_b128 v[12:15], v5 offset:0
    s_waitcnt lgkmcnt(0)
    v_mfma_f32_32x32x16_bf16 v[36:51], v[12:15], v[8:11], 0
    v_add_u32 v5, 2048, v5
    s_nop 7
    s_nop 7
    v_max3_f32 v3, v3, v36, v37
    v_max3_f32 v3, v3, v38, v39
    v_max3_f32 v3, v3, v40, v41
    v_max3_f32 v3, v3, v42, v43
    v_max3_f32 v3, v3, v44, v45
    v_max3_f32 v3, v3, v46, v47
    v_max3_f32 v3, v3, v48, v49
    v_max3_f32 v3, v3, v50, v51
    s_add_u32 s6, s6, 1
    s_cmp_lt_u32 s6, 64
    s_cbranch_scc1 A_MAXLOOP
    v_mov_b32 v5, v2
    v_mov_b32 v152, 0
    v_mov_b32 v153, 0
    v_mov_b32 v154, 0
    v_mov_b32 v155, 0
    v_mov_b32 v156, 0
    v_mov_b32 v157, 0
    v_mov_b32 v158, 0
    v_mov_b32 v159, 0
    v_mov_b32 v160, 0
    v_mov_b32 v161, 0
    v_mov_b32 v162, 0
    v_mov_b32 v163, 0
    v_mov_b32 v164, 0
    v_mov_b32 v165, 0
    v_mov_b32 v166, 0
    v_mov_b32 v167, 0
    s_branch A_SETMAX
A_FIN:
    v_rcp_f32 v3, v160
    s_waitcnt vmcnt(0)
    v_mul_f32 v3, v3, v7
    v_mul_f32 v152, v152, v3
    v_mul_f32 v153, v153, v3
    v_mul_f32 v154, v154, v3
    v_mul_f32 v155, v155, v3
    v_mul_f32 v156, v156, v3
    v_mul_f32 v157, v157, v3
    v_mul_f32 v158, v158, v3
    v_mul_f32 v159, v159, v3
    v_cvt_pk_bf16_f32 v152, v152, v153
    v_cvt_pk_bf16_f32 v153, v154, v155
    v_cvt_pk_bf16_f32 v154, v156, v157
    v_cvt_pk_bf16_f32 v155, v158, v159
    v_min_u32 v152, -2, v152
    v_min_u32 v153, -2, v153
    v_min_u32 v154, -2, v154
    v_min_u32 v155, -2, v155
    buffer_store_dwordx4 v[152:155], v2, s[40:43], s12 offen sc1
    s_endpgm
K_END:
    s_endpgm
.section .rodata,"a"
.p2align 6
.amdhsa_kernel gated_mix__mha_block__dense_activation_mish__prompt_kernel
  .amdhsa_next_free_vgpr 168
  .amdhsa_next_free_sgpr 84
  .amdhsa_accum_offset 168
  .amdhsa_group_segment_fixed_size 0
  .amdhsa_kernarg_size 88
  .amdhsa_user_sgpr_count 2
  .amdhsa_user_sgpr_kernarg_segment_ptr 1
  .amdhsa_system_sgpr_workgroup_id_x 1
.end_amdhsa_kernel
```
